```python
import torch

def _softmax(x, axis=-1):
    return torch.softmax(x, dim=axis)
def _gelu(x):
    return torch.nn.functional.gelu(x, approximate="tanh")
def _silu(x):
    return torch.nn.functional.silu(x)
def _sigmoid(x):
    return torch.sigmoid(x)
def _layernorm(x, axis=-1, eps=1e-5):
    m = x.mean(dim=axis, keepdim=True)
    v = x.var(dim=axis, keepdim=True, unbiased=False)
    return (x - m) / torch.sqrt(v + eps)
def _scatter_add(tgt, idx, src, axis=0):
    return tgt.clone().index_add_(axis, idx, src)
def _segment_sum(src, seg, n):
    out = torch.zeros((n,) + src.shape[1:], dtype=src.dtype)
    return out.index_add_(0, seg, src)
def _pad(x, pw):
    flat = tuple(v for pair in reversed(pw) for v in pair)
    return torch.nn.functional.pad(x, flat)

kernel_name = 'sequential_preLN__mha_block__glu_gated_bilinear__prompt'

def setup_inputs():

    _w = (lambda a: (lambda t: t.to(torch.bfloat16) if t.is_floating_point() else t)(torch.as_tensor(a)))
    def _A_setup():
        B, S, D, H = 1, 2048, 640, 32
        return {
            "x": _w((lambda *s: torch.randn(*s, dtype=torch.bfloat16) * 0.05)(B, S, D)),
            "wqkv": _w((lambda *s: torch.randn(*s, dtype=torch.bfloat16) * 0.05)(D, 3 * D)),
            "wo": _w((lambda *s: torch.randn(*s, dtype=torch.bfloat16) * 0.05)(D, D)),
        }
    _A_in = _A_setup()

    def _B_setup():
        B, S, D, F = 1, 2048, 640, 1536
        return {
            "x": _w((lambda *s: torch.randn(*s, dtype=torch.bfloat16) * 0.05)(B, S, D)),
            "w_gate": _w((lambda *s: torch.randn(*s, dtype=torch.bfloat16) * 0.8)(D, F) * (D ** -0.5)),
            "w_up": _w((lambda *s: torch.randn(*s, dtype=torch.bfloat16) * 0.8)(D, F) * (D ** -0.5)),
            "w_down": _w((lambda *s: torch.randn(*s, dtype=torch.bfloat16) * 0.8)(F, D) * (F ** -0.5)),
        }
    _B_in = _B_setup()

    return {
        "A_x": _A_in["x"],
        "A_wqkv": _A_in["wqkv"],
        "A_wo": _A_in["wo"],
        "B_x": _B_in["x"],
        "B_w_gate": _B_in["w_gate"],
        "B_w_up": _B_in["w_up"],
        "B_w_down": _B_in["w_down"],
    }

def reference(A_x, A_wqkv, A_wo, B_x, B_w_gate, B_w_up, B_w_down):
    def _A_ref(x, wqkv, wo):
        B, S, D = x.shape
        H = 32
        Dh = D // H
        qkv = (lambda x, *d: x.permute(*d))((x @ wqkv).reshape(B, S, 3, H, Dh), 2, 0, 3, 1, 4)
        q, k, v = qkv[0], qkv[1], qkv[2]
        scores = torch.einsum("bhqd,bhkd->bhqk", q, k) * (Dh ** -0.5)
        p = _softmax(scores, axis=-1)
        o = torch.einsum("bhqk,bhkd->bhqd", p, v)
        return (lambda x, *d: x.permute(*d))(o, 0, 2, 1, 3).reshape(B, S, D) @ wo

    def _B_ref(x, w_gate, w_up, w_down):
        g = torch.einsum("bsd,df->bsf", x, w_gate)
        u = torch.einsum("bsd,df->bsf", x, w_up)
        h = g * u
        return torch.einsum("bsf,fd->bsd", h, w_down)

    x = A_x
    h = x + _A_ref(_layernorm(x, axis=-1), A_wqkv, A_wo)
    h2 = h + _B_ref(_layernorm(h, axis=-1), B_w_gate, B_w_up, B_w_down)
    return h2
```

```asm
; @launch kernel=kf_fused_kernel grid=(256,1,1) block=(640,1,1) lds=163840
.amdgcn_target "amdgcn-amd-amdhsa--gfx950"
.text
.globl kf_fused_kernel
.p2align 8
.type kf_fused_kernel,@function
kf_fused_kernel:
    s_load_dwordx4 s[4:7], s[0:1], 0
    s_load_dwordx4 s[8:11], s[0:1], 64
    s_cmp_ge_u32 s2, 256
    s_cbranch_scc1 L_kf_fus_end_1
    v_lshrrev_b32 v1, 6, v0
    s_and_b32 s29, s2, 3
    s_lshl_b32 s29, s29, 2
    v_readfirstlane_b32 s20, v1
    v_and_b32 v1, 63, v0
    s_bfe_u32 s21, s2, 0x20003
    s_add_u32 s29, s29, s21
    s_bfe_u32 s30, s2, 0x10002
    s_lshl_b32 s30, s30, 3
    s_lshr_b32 s21, s2, 5
    s_add_u32 s30, s30, s21
    s_cmp_ge_u32 s20, 8
    s_cbranch_scc1 L_f_help
    s_cmp_ge_u32 s30, 15
    s_cbranch_scc1 L_f_idle
    s_cmp_lt_u32 s20, 4
    s_cbranch_scc1 L_k1_compute
    s_sub_u32 s31, s20, 4
    s_lshl_b32 s21, s29, 7
    s_lshl_b32 s22, s31, 5
    s_add_u32 s21, s21, s22
    v_bfe_u32 v12, v1, 2, 3
    v_add_u32 v12, s21, v12
    s_movk_i32 s22, 1280
    v_mul_lo_u32 v12, v12, s22
    v_lshrrev_b32 v13, 5, v1
    v_lshl_add_u32 v12, v13, 6, v12
    v_and_b32 v13, 3, v1
    v_xor_b32 v14, 0, v13
    v_lshl_add_u32 v4, v14, 4, v12
    v_xor_b32 v14, 1, v13
    v_lshl_add_u32 v5, v14, 4, v12
    v_add_u32 v5, 9216, v5
    v_xor_b32 v14, 2, v13
    v_lshl_add_u32 v6, v14, 4, v12
    v_add_u32 v6, 18432, v6
    v_xor_b32 v14, 3, v13
    v_lshl_add_u32 v7, v14, 4, v12
    v_add_u32 v7, 27648, v7
    s_lshl_b32 s21, s31, 4
    v_lshrrev_b32 v12, 4, v1
    v_lshlrev_b32 v13, 2, v12
    v_add_u32 v12, s21, v12
    s_movk_i32 s22, 3840
    v_mul_lo_u32 v12, v12, s22
    v_and_b32 v14, 15, v1
    v_xor_b32 v14, v14, v13
    v_lshl_add_u32 v12, v14, 4, v12
    s_lshl_b32 s21, s30, 8
    v_add_u32 v8, s21, v12
    v_add_u32 v9, 14336, v8
    v_add_u32 v10, 28672, v8
    v_add_u32 v11, 43008, v8
    s_mov_b32 s35, 0
    s_lshl_b32 s34, s31, 12
    s_waitcnt lgkmcnt(0)
    s_mov_b32 s36, s4
    s_mov_b32 s37, s5
    s_mov_b32 s38, 0x280000
    s_mov_b32 s39, 0x20000
    s_mov_b32 s40, s6
    s_mov_b32 s41, s7
    s_mov_b32 s42, 0x258000
    s_mov_b32 s43, 0x20000
    s_add_u32 m0, s34, 0
    s_lshl_b32 s32, s35, 7
    s_mul_i32 s33, s35, 245760
    buffer_load_dwordx4 v4, s[36:39], s32 offen offset:0  lds
    buffer_load_dwordx4 v5, s[36:39], s32 offen offset:1024  lds
    buffer_load_dwordx4 v6, s[36:39], s32 offen offset:2048  lds
    buffer_load_dwordx4 v7, s[36:39], s32 offen offset:3072  lds
    s_add_u32 m0, s34, 16384
    s_add_u32 s35, s35, 1
    s_cmp_eq_u32 s35, 10
    s_cselect_b32 s35, 0, s35
    buffer_load_dwordx4 v8, s[40:43], s33 offen offset:0  lds
    buffer_load_dwordx4 v9, s[40:43], s33 offen offset:1024  lds
    buffer_load_dwordx4 v10, s[40:43], s33 offen offset:2048  lds
    buffer_load_dwordx4 v11, s[40:43], s33 offen offset:3072  lds
    s_add_u32 m0, s34, 32768
    s_lshl_b32 s32, s35, 7
    s_mul_i32 s33, s35, 245760
    buffer_load_dwordx4 v4, s[36:39], s32 offen offset:0  lds
    buffer_load_dwordx4 v5, s[36:39], s32 offen offset:1024  lds
    buffer_load_dwordx4 v6, s[36:39], s32 offen offset:2048  lds
    buffer_load_dwordx4 v7, s[36:39], s32 offen offset:3072  lds
    s_add_u32 m0, s34, 49152
    s_add_u32 s35, s35, 1
    s_cmp_eq_u32 s35, 10
    s_cselect_b32 s35, 0, s35
    buffer_load_dwordx4 v8, s[40:43], s33 offen offset:0  lds
    buffer_load_dwordx4 v9, s[40:43], s33 offen offset:1024  lds
    buffer_load_dwordx4 v10, s[40:43], s33 offen offset:2048  lds
    buffer_load_dwordx4 v11, s[40:43], s33 offen offset:3072  lds
    s_waitcnt vmcnt(8)
    s_barrier
    s_add_u32 m0, s34, 65536
    s_lshl_b32 s32, s35, 7
    s_mul_i32 s33, s35, 245760
    buffer_load_dwordx4 v4, s[36:39], s32 offen offset:0  lds
    buffer_load_dwordx4 v5, s[36:39], s32 offen offset:1024  lds
    buffer_load_dwordx4 v6, s[36:39], s32 offen offset:2048  lds
    buffer_load_dwordx4 v7, s[36:39], s32 offen offset:3072  lds
    s_add_u32 m0, s34, 81920
    s_add_u32 s35, s35, 1
    s_cmp_eq_u32 s35, 10
    s_cselect_b32 s35, 0, s35
    buffer_load_dwordx4 v8, s[40:43], s33 offen offset:0  lds
    buffer_load_dwordx4 v9, s[40:43], s33 offen offset:1024  lds
    buffer_load_dwordx4 v10, s[40:43], s33 offen offset:2048  lds
    buffer_load_dwordx4 v11, s[40:43], s33 offen offset:3072  lds
    s_waitcnt vmcnt(8)
    s_barrier
    s_add_u32 m0, s34, 0
    s_lshl_b32 s32, s35, 7
    s_mul_i32 s33, s35, 245760
    buffer_load_dwordx4 v4, s[36:39], s32 offen offset:0  lds
    buffer_load_dwordx4 v5, s[36:39], s32 offen offset:1024  lds
    buffer_load_dwordx4 v6, s[36:39], s32 offen offset:2048  lds
    buffer_load_dwordx4 v7, s[36:39], s32 offen offset:3072  lds
    s_add_u32 m0, s34, 16384
    s_add_u32 s35, s35, 1
    s_cmp_eq_u32 s35, 10
    s_cselect_b32 s35, 0, s35
    buffer_load_dwordx4 v8, s[40:43], s33 offen offset:0  lds
    buffer_load_dwordx4 v9, s[40:43], s33 offen offset:1024  lds
    buffer_load_dwordx4 v10, s[40:43], s33 offen offset:2048  lds
    buffer_load_dwordx4 v11, s[40:43], s33 offen offset:3072  lds
    s_waitcnt vmcnt(8)
    s_barrier
    s_add_u32 m0, s34, 32768
    s_lshl_b32 s32, s35, 7
    s_mul_i32 s33, s35, 245760
    buffer_load_dwordx4 v4, s[36:39], s32 offen offset:0  lds
    buffer_load_dwordx4 v5, s[36:39], s32 offen offset:1024  lds
    buffer_load_dwordx4 v6, s[36:39], s32 offen offset:2048  lds
    buffer_load_dwordx4 v7, s[36:39], s32 offen offset:3072  lds
    s_add_u32 m0, s34, 49152
    s_add_u32 s35, s35, 1
    s_cmp_eq_u32 s35, 10
    s_cselect_b32 s35, 0, s35
    buffer_load_dwordx4 v8, s[40:43], s33 offen offset:0  lds
    buffer_load_dwordx4 v9, s[40:43], s33 offen offset:1024  lds
    buffer_load_dwordx4 v10, s[40:43], s33 offen offset:2048  lds
    buffer_load_dwordx4 v11, s[40:43], s33 offen offset:3072  lds
    s_waitcnt vmcnt(8)
    s_barrier
    s_add_u32 m0, s34, 65536
    s_lshl_b32 s32, s35, 7
    s_mul_i32 s33, s35, 245760
    buffer_load_dwordx4 v4, s[36:39], s32 offen offset:0  lds
    buffer_load_dwordx4 v5, s[36:39], s32 offen offset:1024  lds
    buffer_load_dwordx4 v6, s[36:39], s32 offen offset:2048  lds
    buffer_load_dwordx4 v7, s[36:39], s32 offen offset:3072  lds
    s_add_u32 m0, s34, 81920
    s_add_u32 s35, s35, 1
    s_cmp_eq_u32 s35, 10
    s_cselect_b32 s35, 0, s35
    buffer_load_dwordx4 v8, s[40:43], s33 offen offset:0  lds
    buffer_load_dwordx4 v9, s[40:43], s33 offen offset:1024  lds
    buffer_load_dwordx4 v10, s[40:43], s33 offen offset:2048  lds
    buffer_load_dwordx4 v11, s[40:43], s33 offen offset:3072  lds
    s_waitcnt vmcnt(8)
    s_barrier
    s_add_u32 m0, s34, 0
    s_lshl_b32 s32, s35, 7
    s_mul_i32 s33, s35, 245760
    buffer_load_dwordx4 v4, s[36:39], s32 offen offset:0  lds
    buffer_load_dwordx4 v5, s[36:39], s32 offen offset:1024  lds
    buffer_load_dwordx4 v6, s[36:39], s32 offen offset:2048  lds
    buffer_load_dwordx4 v7, s[36:39], s32 offen offset:3072  lds
    s_add_u32 m0, s34, 16384
    s_add_u32 s35, s35, 1
    s_cmp_eq_u32 s35, 10
    s_cselect_b32 s35, 0, s35
    buffer_load_dwordx4 v8, s[40:43], s33 offen offset:0  lds
    buffer_load_dwordx4 v9, s[40:43], s33 offen offset:1024  lds
    buffer_load_dwordx4 v10, s[40:43], s33 offen offset:2048  lds
    buffer_load_dwordx4 v11, s[40:43], s33 offen offset:3072  lds
    s_waitcnt vmcnt(8)
    s_barrier
    s_add_u32 m0, s34, 32768
    s_lshl_b32 s32, s35, 7
    s_mul_i32 s33, s35, 245760
    buffer_load_dwordx4 v4, s[36:39], s32 offen offset:0  lds
    buffer_load_dwordx4 v5, s[36:39], s32 offen offset:1024  lds
    buffer_load_dwordx4 v6, s[36:39], s32 offen offset:2048  lds
    buffer_load_dwordx4 v7, s[36:39], s32 offen offset:3072  lds
    s_add_u32 m0, s34, 49152
    s_add_u32 s35, s35, 1
    s_cmp_eq_u32 s35, 10
    s_cselect_b32 s35, 0, s35
    buffer_load_dwordx4 v8, s[40:43], s33 offen offset:0  lds
    buffer_load_dwordx4 v9, s[40:43], s33 offen offset:1024  lds
    buffer_load_dwordx4 v10, s[40:43], s33 offen offset:2048  lds
    buffer_load_dwordx4 v11, s[40:43], s33 offen offset:3072  lds
    s_waitcnt vmcnt(8)
    s_barrier
    s_add_u32 m0, s34, 65536
    s_lshl_b32 s32, s35, 7
    s_mul_i32 s33, s35, 245760
    buffer_load_dwordx4 v4, s[36:39], s32 offen offset:0  lds
    buffer_load_dwordx4 v5, s[36:39], s32 offen offset:1024  lds
    buffer_load_dwordx4 v6, s[36:39], s32 offen offset:2048  lds
    buffer_load_dwordx4 v7, s[36:39], s32 offen offset:3072  lds
    s_add_u32 m0, s34, 81920
    s_add_u32 s35, s35, 1
    s_cmp_eq_u32 s35, 10
    s_cselect_b32 s35, 0, s35
    buffer_load_dwordx4 v8, s[40:43], s33 offen offset:0  lds
    buffer_load_dwordx4 v9, s[40:43], s33 offen offset:1024  lds
    buffer_load_dwordx4 v10, s[40:43], s33 offen offset:2048  lds
    buffer_load_dwordx4 v11, s[40:43], s33 offen offset:3072  lds
    s_waitcnt vmcnt(8)
    s_barrier
    s_add_u32 m0, s34, 0
    s_lshl_b32 s32, s35, 7
    s_mul_i32 s33, s35, 245760
    buffer_load_dwordx4 v4, s[36:39], s32 offen offset:0  lds
    buffer_load_dwordx4 v5, s[36:39], s32 offen offset:1024  lds
    buffer_load_dwordx4 v6, s[36:39], s32 offen offset:2048  lds
    buffer_load_dwordx4 v7, s[36:39], s32 offen offset:3072  lds
    s_add_u32 m0, s34, 16384
    s_add_u32 s35, s35, 1
    s_cmp_eq_u32 s35, 10
    s_cselect_b32 s35, 0, s35
    buffer_load_dwordx4 v8, s[40:43], s33 offen offset:0  lds
    buffer_load_dwordx4 v9, s[40:43], s33 offen offset:1024  lds
    buffer_load_dwordx4 v10, s[40:43], s33 offen offset:2048  lds
    buffer_load_dwordx4 v11, s[40:43], s33 offen offset:3072  lds
    s_waitcnt vmcnt(8)
    s_barrier
    s_waitcnt vmcnt(0)
    s_barrier
    s_barrier
    s_branch L_att_pre
L_k1_compute:
    s_lshr_b32 s31, s20, 1
    s_and_b32 s32, s20, 1
    v_mov_b32 v112, 0x3f803f80
    v_mov_b32 v113, 0x3f803f80
    v_lshrrev_b32 v126, 5, v1
    v_and_b32 v127, 31, v1
    s_lshl_b32 s21, s20, 12
    v_lshrrev_b32 v129, 3, v127
    v_and_b32 v128, 7, v127
    v_lshlrev_b32 v128, 6, v128
    v_lshl_add_u32 v128, v129, 10, v128
    v_add_u32 v128, s21, v128
    v_or_b32 v130, 0, v126
    v_xor_b32 v130, v130, v129
    v_lshl_add_u32 v120, v130, 4, v128
    v_xor_b32 v122, 4096, v120
    v_or_b32 v130, 2, v126
    v_xor_b32 v130, v130, v129
    v_lshl_add_u32 v121, v130, 4, v128
    v_xor_b32 v123, 4096, v121
    v_bfe_u32 v128, v1, 2, 2
    v_lshl_add_u32 v129, v126, 3, v128
    v_lshlrev_b32 v129, 8, v129
    v_and_b32 v130, 1, v1
    v_lshl_add_u32 v129, v130, 3, v129
    v_add_u32 v129, 16384, v129
    v_bfe_u32 v130, v1, 4, 1
    v_lshlrev_b32 v130, 1, v130
    v_bfe_u32 v131, v1, 1, 1
    v_or_b32 v130, v130, v131
    s_lshl_b32 s21, s32, 1
    s_add_u32 s21, s21, s31
    s_lshl_b32 s22, s21, 2
    v_or_b32 v130, s22, v130
    v_lshlrev_b32 v128, 2, v128
    v_xor_b32 v130, v130, v128
    v_lshl_add_u32 v124, v130, 4, v129
    v_xor_b32 v125, 64, v124
    s_mov_b32 s37, s21
    s_lshl_b32 s36, s29, 2
    s_add_u32 s36, s36, s20
    v_mov_b32 v114, v120
    v_mov_b32 v115, v121
    v_mov_b32 v116, v122
    v_mov_b32 v117, v123
    v_mov_b32 v118, v124
    v_mov_b32 v119, v125
    v_mov_b64 v[100:101], 0
    v_mov_b64 v[102:103], 0
    v_mov_b64 v[104:105], 0
    v_mov_b64 v[106:107], 0
    v_mov_b64 v[108:109], 0
    v_mov_b64 v[110:111], 0
    s_nop 1
    v_mfma_f32_32x32x16_bf16 v[4:19], v[100:103], v[100:103], 0
    v_mfma_f32_32x32x16_bf16 v[20:35], v[100:103], v[100:103], 0
    v_mfma_f32_32x32x16_bf16 v[36:51], v[100:103], v[100:103], 0
    v_mfma_f32_32x32x16_bf16 v[52:67], v[100:103], v[100:103], 0
    v_lshlrev_b32 v2, 4, v1
    s_lshl_b32 s24, s2, 7
    s_add_u32 s24, s24, 26345472
    s_mov_b32 s14, 0x1930000
    s_mov_b32 s15, 0x20000
    s_mov_b32 s18, 256
    s_mov_b32 s19, 0x20000
    s_waitcnt lgkmcnt(0)
    s_mov_b64 s[12:13], s[10:11]
    s_mov_b64 s[16:17], s[8:9]
    s_cmp_ge_u32 s30, 10
    s_cbranch_scc1 L_kf_fus_vpath_2
    s_mov_b32 s35, 1.0
    s_cmp_lt_u32 s30, 5
    s_cselect_b32 s35, 0x3ea52b5c, s35
    v_mul_u32_u24 v134, 32768, v126
    s_lshl_b32 s21, s36, 9
    v_lshl_add_u32 v134, v127, 4, v134
    v_add_u32 v136, s21, v134
    s_xor_b32 s21, s21, 512
    v_add_u32 v137, s21, v134
    s_xor_b32 s21, s37, 0
    s_lshl2_add_u32 s21, s30, s21
    s_mul_i32 s38, s21, 131072
    s_xor_b32 s21, s37, 1
    s_lshl2_add_u32 s21, s30, s21
    s_mul_i32 s39, s21, 131072
    s_mov_b32 s33, 0
    s_mov_b32 s34, 10
    s_barrier
    ds_read_b128 v[68:71], v114 offset:0
    ds_read_b64_tr_b16 v[84:85], v118 offset:0
    ds_read_b64_tr_b16 v[86:87], v118 offset:1024
    ds_read_b128 v[72:75], v116 offset:0
    ds_read_b64_tr_b16 v[88:89], v119 offset:0
    ds_read_b64_tr_b16 v[90:91], v119 offset:1024
L_kf_fus_loop_3:
    s_waitcnt lgkmcnt(3)
    v_mfma_f32_4x4x4_16b_bf16 v[100:103], v[112:113], v[68:69], v[100:103]
    v_mfma_f32_4x4x4_16b_bf16 v[104:107], v[68:69], v[68:69], v[104:107]
    v_mfma_f32_4x4x4_16b_bf16 v[108:111], v[112:113], v[84:85], v[108:111]
    v_mfma_f32_4x4x4_16b_bf16 v[100:103], v[112:113], v[70:71], v[100:103]
    v_mfma_f32_4x4x4_16b_bf16 v[104:107], v[70:71], v[70:71], v[104:107]
    v_mfma_f32_4x4x4_16b_bf16 v[108:111], v[112:113], v[86:87], v[108:111]
    s_waitcnt lgkmcnt(0)
    v_mfma_f32_32x32x16_bf16 v[4:19], v[84:87], v[68:71], v[4:19]
    ds_read_b128 v[76:79], v115 offset:0
    ds_read_b64_tr_b16 v[92:93], v118 offset:4096
    ds_read_b64_tr_b16 v[94:95], v118 offset:5120
    v_mfma_f32_32x32x16_bf16 v[20:35], v[88:91], v[68:71], v[20:35]
    ds_read_b128 v[80:83], v117 offset:0
    ds_read_b64_tr_b16 v[96:97], v119 offset:4096
    ds_read_b64_tr_b16 v[98:99], v119 offset:5120
    v_mfma_f32_32x32x16_bf16 v[52:67], v[88:91], v[72:75], v[52:67]
    v_mfma_f32_32x32x16_bf16 v[36:51], v[84:87], v[72:75], v[36:51]
    s_waitcnt lgkmcnt(3)
    v_mfma_f32_4x4x4_16b_bf16 v[100:103], v[112:113], v[76:77], v[100:103]
    v_mfma_f32_4x4x4_16b_bf16 v[104:107], v[76:77], v[76:77], v[104:107]
    v_mfma_f32_4x4x4_16b_bf16 v[108:111], v[112:113], v[92:93], v[108:111]
    v_mfma_f32_4x4x4_16b_bf16 v[100:103], v[112:113], v[78:79], v[100:103]
    v_mfma_f32_4x4x4_16b_bf16 v[104:107], v[78:79], v[78:79], v[104:107]
    v_mfma_f32_4x4x4_16b_bf16 v[108:111], v[112:113], v[94:95], v[108:111]
    s_waitcnt lgkmcnt(0)
    v_mfma_f32_32x32x16_bf16 v[4:19], v[92:95], v[76:79], v[4:19]
    ds_read_b128 v[68:71], v114 offset:512
    ds_read_b64_tr_b16 v[84:85], v118 offset:8192
    ds_read_b64_tr_b16 v[86:87], v118 offset:9216
    v_mfma_f32_32x32x16_bf16 v[20:35], v[96:99], v[76:79], v[20:35]
    ds_read_b128 v[72:75], v116 offset:512
    ds_read_b64_tr_b16 v[88:89], v119 offset:8192
    ds_read_b64_tr_b16 v[90:91], v119 offset:9216
    v_mfma_f32_32x32x16_bf16 v[52:67], v[96:99], v[80:83], v[52:67]
    s_add_u32 s33, s33, 32768
    s_cmp_eq_u32 s33, 98304
    s_cselect_b32 s33, 0, s33
    s_sub_u32 s34, s34, 1
    v_mfma_f32_32x32x16_bf16 v[36:51], v[92:95], v[80:83], v[36:51]
    s_waitcnt lgkmcnt(3)
    v_mfma_f32_4x4x4_16b_bf16 v[100:103], v[112:113], v[68:69], v[100:103]
    v_mfma_f32_4x4x4_16b_bf16 v[104:107], v[68:69], v[68:69], v[104:107]
    v_mfma_f32_4x4x4_16b_bf16 v[108:111], v[112:113], v[84:85], v[108:111]
    v_mfma_f32_4x4x4_16b_bf16 v[100:103], v[112:113], v[70:71], v[100:103]
    v_mfma_f32_4x4x4_16b_bf16 v[104:107], v[70:71], v[70:71], v[104:107]
    v_mfma_f32_4x4x4_16b_bf16 v[108:111], v[112:113], v[86:87], v[108:111]
    s_waitcnt lgkmcnt(0)
    v_mfma_f32_32x32x16_bf16 v[4:19], v[84:87], v[68:71], v[4:19]
    ds_read_b128 v[76:79], v115 offset:512
    ds_read_b64_tr_b16 v[92:93], v118 offset:12288
    ds_read_b64_tr_b16 v[94:95], v118 offset:13312
    v_mfma_f32_32x32x16_bf16 v[20:35], v[88:91], v[68:71], v[20:35]
    ds_read_b128 v[80:83], v117 offset:512
    ds_read_b64_tr_b16 v[96:97], v119 offset:12288
    ds_read_b64_tr_b16 v[98:99], v119 offset:13312
    v_mfma_f32_32x32x16_bf16 v[52:67], v[88:91], v[72:75], v[52:67]
    v_add_u32 v114, s33, v120
    v_add_u32 v115, s33, v121
    v_add_u32 v116, s33, v122
    s_cmp_eq_u32 s34, 0
    v_mfma_f32_32x32x16_bf16 v[36:51], v[84:87], v[72:75], v[36:51]
    v_add_u32 v117, s33, v123
    v_add_u32 v118, s33, v124
    v_add_u32 v119, s33, v125
    s_waitcnt lgkmcnt(3)
    v_mfma_f32_4x4x4_16b_bf16 v[100:103], v[112:113], v[76:77], v[100:103]
    v_mfma_f32_4x4x4_16b_bf16 v[104:107], v[76:77], v[76:77], v[104:107]
    v_mfma_f32_4x4x4_16b_bf16 v[108:111], v[112:113], v[92:93], v[108:111]
    v_mfma_f32_4x4x4_16b_bf16 v[100:103], v[112:113], v[78:79], v[100:103]
    v_mfma_f32_4x4x4_16b_bf16 v[104:107], v[78:79], v[78:79], v[104:107]
    v_mfma_f32_4x4x4_16b_bf16 v[108:111], v[112:113], v[94:95], v[108:111]
    s_waitcnt lgkmcnt(0)
    s_cbranch_scc1 L_kf_fus_last_4
    v_mfma_f32_32x32x16_bf16 v[4:19], v[92:95], v[76:79], v[4:19]
    s_barrier
    ds_read_b128 v[68:71], v114 offset:0
    ds_read_b64_tr_b16 v[84:85], v118 offset:0
    ds_read_b64_tr_b16 v[86:87], v118 offset:1024
    v_mfma_f32_32x32x16_bf16 v[20:35], v[96:99], v[76:79], v[20:35]
    ds_read_b128 v[72:75], v116 offset:0
    ds_read_b64_tr_b16 v[88:89], v119 offset:0
    ds_read_b64_tr_b16 v[90:91], v119 offset:1024
    v_mfma_f32_32x32x16_bf16 v[52:67], v[96:99], v[80:83], v[52:67]
    v_mfma_f32_32x32x16_bf16 v[36:51], v[92:95], v[80:83], v[36:51]
    s_branch L_kf_fus_loop_3
L_kf_fus_last_4:
    v_mfma_f32_32x32x16_bf16 v[4:19], v[92:95], v[76:79], v[4:19]
    v_mfma_f32_32x32x16_bf16 v[20:35], v[96:99], v[76:79], v[20:35]
    v_mfma_f32_32x32x16_bf16 v[52:67], v[96:99], v[80:83], v[52:67]
    v_mfma_f32_32x32x16_bf16 v[36:51], v[92:95], v[80:83], v[36:51]
    v_and_b32 v130, 1, v1
    v_cmp_eq_u32 vcc, 1, v130
    v_and_b32 v130, 2, v1
    s_nop 3
    v_cndmask_b32 v129, v104, v105, vcc
    v_cndmask_b32 v131, v106, v107, vcc
    v_cmp_eq_u32 vcc, 2, v130
    v_mov_b32 v128, v100
    v_mov_b32 v134, v108
    v_cndmask_b32 v129, v129, v131, vcc
    v_permlane32_swap_b32 v128, v100
    v_mov_b32 v131, v129
    v_permlane32_swap_b32 v134, v108
    v_add_f32 v128, v128, v100
    v_permlane32_swap_b32 v129, v131
    v_add_f32 v134, v134, v108
    s_nop 0
    v_add_f32 v129, v129, v131
    v_mul_f32 v128, 0x3acccccd, v128
    v_mul_f32 v129, 0x3acccccd, v129
    v_fma_f32 v129, -v128, v128, v129
    v_max_f32 v129, 0, v129
    v_cvt_pk_bf16_f32 v130, v128, v129
    v_and_b32 v131, 0xffff0000, v130
    v_lshlrev_b32 v130, 16, v130
    v_add_f32 v131, 0x3727c5ac, v131
    v_sub_f32 v132, 0, v130
    v_cvt_pk_bf16_f32 v131, v131, v131
    v_and_b32 v131, 0xffff0000, v131
    v_sqrt_f32 v131, v131
    s_nop 0
    v_cvt_pk_bf16_f32 v131, v131, v131
    v_and_b32 v131, 0xffff0000, v131
    v_rcp_f32 v133, v131
    s_nop 0
    v_mul_f32 v133, s35, v133
    s_lshl_b32 s21, s20, 7
    v_lshl_add_u32 v130, v127, 2, s21
    s_lshl_b32 s21, s37, 7
    v_lshl_add_u32 v131, v127, 2, s21
    v_add_u32 v130, 161536, v130
    v_add_u32 v131, 161536, v131
    ds_write2_b32 v130, v132, v133 offset1:128
    ds_write_b32 v131, v134 offset:1024
    s_waitcnt lgkmcnt(0)
    s_barrier
    buffer_load_dword v3, off, s[16:19], 0 sc1
    v_xor_b32 v128, 128, v130
    ds_read2_b32 v[102:103], v128 offset1:128
    s_lshl_b32 s21, s37, 7
    v_lshl_add_u32 v129, v126, 4, s21
    v_add_u32 v129, 162560, v129
    v_xor_b32 v131, 128, v129
    v_mov_b32 v100, v132
    v_mov_b32 v101, v133
    ds_read_b128 v[68:71], v129 offset:0
    ds_read_b128 v[72:75], v129 offset:32
    ds_read_b128 v[76:79], v129 offset:64
    ds_read_b128 v[80:83], v129 offset:96
    ds_read_b128 v[84:87], v131 offset:0
    ds_read_b128 v[88:91], v131 offset:32
    ds_read_b128 v[92:95], v131 offset:64
    ds_read_b128 v[96:99], v131 offset:96
    s_waitcnt lgkmcnt(4)
    v_pk_fma_f32 v[4:5], v[68:69], v[100:101], v[4:5] op_sel:[0,0,0] op_sel_hi:[1,0,1]
    v_pk_fma_f32 v[6:7], v[70:71], v[100:101], v[6:7] op_sel:[0,0,0] op_sel_hi:[1,0,1]
    v_pk_fma_f32 v[8:9], v[72:73], v[100:101], v[8:9] op_sel:[0,0,0] op_sel_hi:[1,0,1]
    v_pk_fma_f32 v[10:11], v[74:75], v[100:101], v[10:11] op_sel:[0,0,0] op_sel_hi:[1,0,1]
    v_pk_fma_f32 v[12:13], v[76:77], v[100:101], v[12:13] op_sel:[0,0,0] op_sel_hi:[1,0,1]
    v_pk_fma_f32 v[14:15], v[78:79], v[100:101], v[14:15] op_sel:[0,0,0] op_sel_hi:[1,0,1]
    v_pk_fma_f32 v[16:17], v[80:81], v[100:101], v[16:17] op_sel:[0,0,0] op_sel_hi:[1,0,1]
    v_pk_fma_f32 v[18:19], v[82:83], v[100:101], v[18:19] op_sel:[0,0,0] op_sel_hi:[1,0,1]
    v_pk_mul_f32 v[4:5], v[4:5], v[100:101] op_sel:[0,1] op_sel_hi:[1,1]
    v_pk_mul_f32 v[6:7], v[6:7], v[100:101] op_sel:[0,1] op_sel_hi:[1,1]
    v_pk_mul_f32 v[8:9], v[8:9], v[100:101] op_sel:[0,1] op_sel_hi:[1,1]
    v_pk_mul_f32 v[10:11], v[10:11], v[100:101] op_sel:[0,1] op_sel_hi:[1,1]
    v_pk_mul_f32 v[12:13], v[12:13], v[100:101] op_sel:[0,1] op_sel_hi:[1,1]
    v_pk_mul_f32 v[14:15], v[14:15], v[100:101] op_sel:[0,1] op_sel_hi:[1,1]
    v_pk_mul_f32 v[16:17], v[16:17], v[100:101] op_sel:[0,1] op_sel_hi:[1,1]
    v_pk_mul_f32 v[18:19], v[18:19], v[100:101] op_sel:[0,1] op_sel_hi:[1,1]
    v_cvt_pk_bf16_f32 v4, v4, v5
    v_cvt_pk_bf16_f32 v5, v6, v7
    v_cvt_pk_bf16_f32 v6, v8, v9
    v_cvt_pk_bf16_f32 v7, v10, v11
    v_cvt_pk_bf16_f32 v8, v12, v13
    v_cvt_pk_bf16_f32 v9, v14, v15
    v_cvt_pk_bf16_f32 v10, v16, v17
    v_cvt_pk_bf16_f32 v11, v18, v19
    s_add_u32 s21, s38, 65536
    v_permlane32_swap_b32 v4, v6
    v_permlane32_swap_b32 v5, v7
    v_permlane32_swap_b32 v8, v10
    v_permlane32_swap_b32 v9, v11
    buffer_store_dwordx4 v[4:7], v136, s[12:15], s38 offen sc1
    buffer_store_dwordx4 v[8:11], v136, s[12:15], s21 offen sc1
    v_pk_fma_f32 v[36:37], v[68:69], v[102:103], v[36:37] op_sel:[0,0,0] op_sel_hi:[1,0,1]
    v_pk_fma_f32 v[38:39], v[70:71], v[102:103], v[38:39] op_sel:[0,0,0] op_sel_hi:[1,0,1]
    v_pk_fma_f32 v[40:41], v[72:73], v[102:103], v[40:41] op_sel:[0,0,0] op_sel_hi:[1,0,1]
    v_pk_fma_f32 v[42:43], v[74:75], v[102:103], v[42:43] op_sel:[0,0,0] op_sel_hi:[1,0,1]
    v_pk_fma_f32 v[44:45], v[76:77], v[102:103], v[44:45] op_sel:[0,0,0] op_sel_hi:[1,0,1]
    v_pk_fma_f32 v[46:47], v[78:79], v[102:103], v[46:47] op_sel:[0,0,0] op_sel_hi:[1,0,1]
    v_pk_fma_f32 v[48:49], v[80:81], v[102:103], v[48:49] op_sel:[0,0,0] op_sel_hi:[1,0,1]
    v_pk_fma_f32 v[50:51], v[82:83], v[102:103], v[50:51] op_sel:[0,0,0] op_sel_hi:[1,0,1]
    v_pk_mul_f32 v[36:37], v[36:37], v[102:103] op_sel:[0,1] op_sel_hi:[1,1]
    v_pk_mul_f32 v[38:39], v[38:39], v[102:103] op_sel:[0,1] op_sel_hi:[1,1]
    v_pk_mul_f32 v[40:41], v[40:41], v[102:103] op_sel:[0,1] op_sel_hi:[1,1]
    v_pk_mul_f32 v[42:43], v[42:43], v[102:103] op_sel:[0,1] op_sel_hi:[1,1]
    v_pk_mul_f32 v[44:45], v[44:45], v[102:103] op_sel:[0,1] op_sel_hi:[1,1]
    v_pk_mul_f32 v[46:47], v[46:47], v[102:103] op_sel:[0,1] op_sel_hi:[1,1]
    v_pk_mul_f32 v[48:49], v[48:49], v[102:103] op_sel:[0,1] op_sel_hi:[1,1]
    v_pk_mul_f32 v[50:51], v[50:51], v[102:103] op_sel:[0,1] op_sel_hi:[1,1]
    v_cvt_pk_bf16_f32 v36, v36, v37
    v_cvt_pk_bf16_f32 v37, v38, v39
    v_cvt_pk_bf16_f32 v38, v40, v41
    v_cvt_pk_bf16_f32 v39, v42, v43
    v_cvt_pk_bf16_f32 v40, v44, v45
    v_cvt_pk_bf16_f32 v41, v46, v47
    v_cvt_pk_bf16_f32 v42, v48, v49
    v_cvt_pk_bf16_f32 v43, v50, v51
    s_add_u32 s21, s38, 65536
    v_permlane32_swap_b32 v36, v38
    v_permlane32_swap_b32 v37, v39
    v_permlane32_swap_b32 v40, v42
    v_permlane32_swap_b32 v41, v43
    buffer_store_dwordx4 v[36:39], v137, s[12:15], s38 offen sc1
    buffer_store_dwordx4 v[40:43], v137, s[12:15], s21 offen sc1
    s_waitcnt lgkmcnt(0)
    v_pk_fma_f32 v[20:21], v[84:85], v[100:101], v[20:21] op_sel:[0,0,0] op_sel_hi:[1,0,1]
    v_pk_fma_f32 v[22:23], v[86:87], v[100:101], v[22:23] op_sel:[0,0,0] op_sel_hi:[1,0,1]
    v_pk_fma_f32 v[24:25], v[88:89], v[100:101], v[24:25] op_sel:[0,0,0] op_sel_hi:[1,0,1]
    v_pk_fma_f32 v[26:27], v[90:91], v[100:101], v[26:27] op_sel:[0,0,0] op_sel_hi:[1,0,1]
    v_pk_fma_f32 v[28:29], v[92:93], v[100:101], v[28:29] op_sel:[0,0,0] op_sel_hi:[1,0,1]
    v_pk_fma_f32 v[30:31], v[94:95], v[100:101], v[30:31] op_sel:[0,0,0] op_sel_hi:[1,0,1]
    v_pk_fma_f32 v[32:33], v[96:97], v[100:101], v[32:33] op_sel:[0,0,0] op_sel_hi:[1,0,1]
    v_pk_fma_f32 v[34:35], v[98:99], v[100:101], v[34:35] op_sel:[0,0,0] op_sel_hi:[1,0,1]
    v_pk_mul_f32 v[20:21], v[20:21], v[100:101] op_sel:[0,1] op_sel_hi:[1,1]
    v_pk_mul_f32 v[22:23], v[22:23], v[100:101] op_sel:[0,1] op_sel_hi:[1,1]
    v_pk_mul_f32 v[24:25], v[24:25], v[100:101] op_sel:[0,1] op_sel_hi:[1,1]
    v_pk_mul_f32 v[26:27], v[26:27], v[100:101] op_sel:[0,1] op_sel_hi:[1,1]
    v_pk_mul_f32 v[28:29], v[28:29], v[100:101] op_sel:[0,1] op_sel_hi:[1,1]
    v_pk_mul_f32 v[30:31], v[30:31], v[100:101] op_sel:[0,1] op_sel_hi:[1,1]
    v_pk_mul_f32 v[32:33], v[32:33], v[100:101] op_sel:[0,1] op_sel_hi:[1,1]
    v_pk_mul_f32 v[34:35], v[34:35], v[100:101] op_sel:[0,1] op_sel_hi:[1,1]
    v_cvt_pk_bf16_f32 v20, v20, v21
    v_cvt_pk_bf16_f32 v21, v22, v23
    v_cvt_pk_bf16_f32 v22, v24, v25
    v_cvt_pk_bf16_f32 v23, v26, v27
    v_cvt_pk_bf16_f32 v24, v28, v29
    v_cvt_pk_bf16_f32 v25, v30, v31
    v_cvt_pk_bf16_f32 v26, v32, v33
    v_cvt_pk_bf16_f32 v27, v34, v35
    s_add_u32 s21, s39, 65536
    v_permlane32_swap_b32 v20, v22
    v_permlane32_swap_b32 v21, v23
    v_permlane32_swap_b32 v24, v26
    v_permlane32_swap_b32 v25, v27
    buffer_store_dwordx4 v[20:23], v136, s[12:15], s39 offen sc1
    buffer_store_dwordx4 v[24:27], v136, s[12:15], s21 offen sc1
    v_pk_fma_f32 v[52:53], v[84:85], v[102:103], v[52:53] op_sel:[0,0,0] op_sel_hi:[1,0,1]
    v_pk_fma_f32 v[54:55], v[86:87], v[102:103], v[54:55] op_sel:[0,0,0] op_sel_hi:[1,0,1]
    v_pk_fma_f32 v[56:57], v[88:89], v[102:103], v[56:57] op_sel:[0,0,0] op_sel_hi:[1,0,1]
    v_pk_fma_f32 v[58:59], v[90:91], v[102:103], v[58:59] op_sel:[0,0,0] op_sel_hi:[1,0,1]
    v_pk_fma_f32 v[60:61], v[92:93], v[102:103], v[60:61] op_sel:[0,0,0] op_sel_hi:[1,0,1]
    v_pk_fma_f32 v[62:63], v[94:95], v[102:103], v[62:63] op_sel:[0,0,0] op_sel_hi:[1,0,1]
    v_pk_fma_f32 v[64:65], v[96:97], v[102:103], v[64:65] op_sel:[0,0,0] op_sel_hi:[1,0,1]
    v_pk_fma_f32 v[66:67], v[98:99], v[102:103], v[66:67] op_sel:[0,0,0] op_sel_hi:[1,0,1]
    v_pk_mul_f32 v[52:53], v[52:53], v[102:103] op_sel:[0,1] op_sel_hi:[1,1]
    v_pk_mul_f32 v[54:55], v[54:55], v[102:103] op_sel:[0,1] op_sel_hi:[1,1]
    v_pk_mul_f32 v[56:57], v[56:57], v[102:103] op_sel:[0,1] op_sel_hi:[1,1]
    v_pk_mul_f32 v[58:59], v[58:59], v[102:103] op_sel:[0,1] op_sel_hi:[1,1]
    v_pk_mul_f32 v[60:61], v[60:61], v[102:103] op_sel:[0,1] op_sel_hi:[1,1]
    v_pk_mul_f32 v[62:63], v[62:63], v[102:103] op_sel:[0,1] op_sel_hi:[1,1]
    v_pk_mul_f32 v[64:65], v[64:65], v[102:103] op_sel:[0,1] op_sel_hi:[1,1]
    v_pk_mul_f32 v[66:67], v[66:67], v[102:103] op_sel:[0,1] op_sel_hi:[1,1]
    v_cvt_pk_bf16_f32 v52, v52, v53
    v_cvt_pk_bf16_f32 v53, v54, v55
    v_cvt_pk_bf16_f32 v54, v56, v57
    v_cvt_pk_bf16_f32 v55, v58, v59
    v_cvt_pk_bf16_f32 v56, v60, v61
    v_cvt_pk_bf16_f32 v57, v62, v63
    v_cvt_pk_bf16_f32 v58, v64, v65
    v_cvt_pk_bf16_f32 v59, v66, v67
    s_add_u32 s21, s39, 65536
    v_permlane32_swap_b32 v52, v54
    v_permlane32_swap_b32 v53, v55
    v_permlane32_swap_b32 v56, v58
    v_permlane32_swap_b32 v57, v59
    buffer_store_dwordx4 v[52:55], v137, s[12:15], s39 offen sc1
    buffer_store_dwordx4 v[56:59], v137, s[12:15], s21 offen sc1
    s_branch L_att_pre
L_kf_fus_vpath_2:
    s_mul_i32 s38, s36, 40960
    s_xor_b32 s21, s36, 1
    s_mul_i32 s39, s21, 40960
    v_mul_u32_u24 v133, 10240, v126
    v_lshl_add_u32 v133, v127, 4, v133
    s_lshl2_add_u32 s21, s30, s37
    s_lshl_b32 s21, s21, 9
    s_add_u32 s22, s21, 5222400
    v_add_u32 v136, s22, v133
    s_xor_b32 s21, s21, 512
    s_add_u32 s22, s21, 5222400
    v_add_u32 v137, s22, v133
    s_mov_b32 s33, 0
    s_mov_b32 s34, 10
    s_barrier
    ds_read_b128 v[68:71], v114 offset:0
    ds_read_b64_tr_b16 v[84:85], v118 offset:0
    ds_read_b64_tr_b16 v[86:87], v118 offset:1024
    ds_read_b128 v[72:75], v116 offset:0
    ds_read_b64_tr_b16 v[88:89], v119 offset:0
    ds_read_b64_tr_b16 v[90:91], v119 offset:1024
L_kf_fus_loop_5:
    s_waitcnt lgkmcnt(3)
    v_mfma_f32_4x4x4_16b_bf16 v[100:103], v[112:113], v[68:69], v[100:103]
    v_mfma_f32_4x4x4_16b_bf16 v[104:107], v[68:69], v[68:69], v[104:107]
    v_mfma_f32_4x4x4_16b_bf16 v[108:111], v[112:113], v[84:85], v[108:111]
    v_mfma_f32_4x4x4_16b_bf16 v[100:103], v[112:113], v[70:71], v[100:103]
    v_mfma_f32_4x4x4_16b_bf16 v[104:107], v[70:71], v[70:71], v[104:107]
    v_mfma_f32_4x4x4_16b_bf16 v[108:111], v[112:113], v[86:87], v[108:111]
    s_waitcnt lgkmcnt(0)
    v_mfma_f32_32x32x16_bf16 v[4:19], v[68:71], v[84:87], v[4:19]
    ds_read_b128 v[76:79], v115 offset:0
    ds_read_b64_tr_b16 v[92:93], v118 offset:4096
    ds_read_b64_tr_b16 v[94:95], v118 offset:5120
    v_mfma_f32_32x32x16_bf16 v[20:35], v[68:71], v[88:91], v[20:35]
    ds_read_b128 v[80:83], v117 offset:0
    ds_read_b64_tr_b16 v[96:97], v119 offset:4096
    ds_read_b64_tr_b16 v[98:99], v119 offset:5120
    v_mfma_f32_32x32x16_bf16 v[52:67], v[72:75], v[88:91], v[52:67]
    v_mfma_f32_32x32x16_bf16 v[36:51], v[72:75], v[84:87], v[36:51]
    s_waitcnt lgkmcnt(3)
    v_mfma_f32_4x4x4_16b_bf16 v[100:103], v[112:113], v[76:77], v[100:103]
    v_mfma_f32_4x4x4_16b_bf16 v[104:107], v[76:77], v[76:77], v[104:107]
    v_mfma_f32_4x4x4_16b_bf16 v[108:111], v[112:113], v[92:93], v[108:111]
    v_mfma_f32_4x4x4_16b_bf16 v[100:103], v[112:113], v[78:79], v[100:103]
    v_mfma_f32_4x4x4_16b_bf16 v[104:107], v[78:79], v[78:79], v[104:107]
    v_mfma_f32_4x4x4_16b_bf16 v[108:111], v[112:113], v[94:95], v[108:111]
    s_waitcnt lgkmcnt(0)
    v_mfma_f32_32x32x16_bf16 v[4:19], v[76:79], v[92:95], v[4:19]
    ds_read_b128 v[68:71], v114 offset:512
    ds_read_b64_tr_b16 v[84:85], v118 offset:8192
    ds_read_b64_tr_b16 v[86:87], v118 offset:9216
    v_mfma_f32_32x32x16_bf16 v[20:35], v[76:79], v[96:99], v[20:35]
    ds_read_b128 v[72:75], v116 offset:512
    ds_read_b64_tr_b16 v[88:89], v119 offset:8192
    ds_read_b64_tr_b16 v[90:91], v119 offset:9216
    v_mfma_f32_32x32x16_bf16 v[52:67], v[80:83], v[96:99], v[52:67]
    s_add_u32 s33, s33, 32768
    s_cmp_eq_u32 s33, 98304
    s_cselect_b32 s33, 0, s33
    s_sub_u32 s34, s34, 1
    v_mfma_f32_32x32x16_bf16 v[36:51], v[80:83], v[92:95], v[36:51]
    s_waitcnt lgkmcnt(3)
    v_mfma_f32_4x4x4_16b_bf16 v[100:103], v[112:113], v[68:69], v[100:103]
    v_mfma_f32_4x4x4_16b_bf16 v[104:107], v[68:69], v[68:69], v[104:107]
    v_mfma_f32_4x4x4_16b_bf16 v[108:111], v[112:113], v[84:85], v[108:111]
    v_mfma_f32_4x4x4_16b_bf16 v[100:103], v[112:113], v[70:71], v[100:103]
    v_mfma_f32_4x4x4_16b_bf16 v[104:107], v[70:71], v[70:71], v[104:107]
    v_mfma_f32_4x4x4_16b_bf16 v[108:111], v[112:113], v[86:87], v[108:111]
    s_waitcnt lgkmcnt(0)
    v_mfma_f32_32x32x16_bf16 v[4:19], v[68:71], v[84:87], v[4:19]
    ds_read_b128 v[76:79], v115 offset:512
    ds_read_b64_tr_b16 v[92:93], v118 offset:12288
    ds_read_b64_tr_b16 v[94:95], v118 offset:13312
    v_mfma_f32_32x32x16_bf16 v[20:35], v[68:71], v[88:91], v[20:35]
    ds_read_b128 v[80:83], v117 offset:512
    ds_read_b64_tr_b16 v[96:97], v119 offset:12288
    ds_read_b64_tr_b16 v[98:99], v119 offset:13312
    v_mfma_f32_32x32x16_bf16 v[52:67], v[72:75], v[88:91], v[52:67]
    v_add_u32 v114, s33, v120
    v_add_u32 v115, s33, v121
    v_add_u32 v116, s33, v122
    s_cmp_eq_u32 s34, 0
    v_mfma_f32_32x32x16_bf16 v[36:51], v[72:75], v[84:87], v[36:51]
    v_add_u32 v117, s33, v123
    v_add_u32 v118, s33, v124
    v_add_u32 v119, s33, v125
    s_waitcnt lgkmcnt(3)
    v_mfma_f32_4x4x4_16b_bf16 v[100:103], v[112:113], v[76:77], v[100:103]
    v_mfma_f32_4x4x4_16b_bf16 v[104:107], v[76:77], v[76:77], v[104:107]
    v_mfma_f32_4x4x4_16b_bf16 v[108:111], v[112:113], v[92:93], v[108:111]
    v_mfma_f32_4x4x4_16b_bf16 v[100:103], v[112:113], v[78:79], v[100:103]
    v_mfma_f32_4x4x4_16b_bf16 v[104:107], v[78:79], v[78:79], v[104:107]
    v_mfma_f32_4x4x4_16b_bf16 v[108:111], v[112:113], v[94:95], v[108:111]
    s_waitcnt lgkmcnt(0)
    s_cbranch_scc1 L_kf_fus_last_6
    v_mfma_f32_32x32x16_bf16 v[4:19], v[76:79], v[92:95], v[4:19]
    s_barrier
    ds_read_b128 v[68:71], v114 offset:0
    ds_read_b64_tr_b16 v[84:85], v118 offset:0
    ds_read_b64_tr_b16 v[86:87], v118 offset:1024
    v_mfma_f32_32x32x16_bf16 v[20:35], v[76:79], v[96:99], v[20:35]
    ds_read_b128 v[72:75], v116 offset:0
    ds_read_b64_tr_b16 v[88:89], v119 offset:0
    ds_read_b64_tr_b16 v[90:91], v119 offset:1024
    v_mfma_f32_32x32x16_bf16 v[52:67], v[80:83], v[96:99], v[52:67]
    v_mfma_f32_32x32x16_bf16 v[36:51], v[80:83], v[92:95], v[36:51]
    s_branch L_kf_fus_loop_5
L_kf_fus_last_6:
    v_mfma_f32_32x32x16_bf16 v[4:19], v[76:79], v[92:95], v[4:19]
    v_mfma_f32_32x32x16_bf16 v[20:35], v[76:79], v[96:99], v[20:35]
    v_mfma_f32_32x32x16_bf16 v[52:67], v[80:83], v[96:99], v[52:67]
    v_mfma_f32_32x32x16_bf16 v[36:51], v[80:83], v[92:95], v[36:51]
    v_and_b32 v130, 1, v1
    v_cmp_eq_u32 vcc, 1, v130
    v_and_b32 v130, 2, v1
    s_nop 3
    v_cndmask_b32 v129, v104, v105, vcc
    v_cndmask_b32 v131, v106, v107, vcc
    v_cmp_eq_u32 vcc, 2, v130
    v_mov_b32 v128, v100
    v_mov_b32 v134, v108
    v_cndmask_b32 v129, v129, v131, vcc
    v_permlane32_swap_b32 v128, v100
    v_mov_b32 v131, v129
    v_permlane32_swap_b32 v134, v108
    v_add_f32 v128, v128, v100
    v_permlane32_swap_b32 v129, v131
    v_add_f32 v134, v134, v108
    s_nop 0
    v_add_f32 v129, v129, v131
    v_mul_f32 v128, 0x3acccccd, v128
    v_mul_f32 v129, 0x3acccccd, v129
    v_fma_f32 v129, -v128, v128, v129
    v_max_f32 v129, 0, v129
    v_cvt_pk_bf16_f32 v130, v128, v129
    v_and_b32 v131, 0xffff0000, v130
    v_lshlrev_b32 v130, 16, v130
    v_add_f32 v131, 0x3727c5ac, v131
    v_sub_f32 v132, 0, v130
    v_cvt_pk_bf16_f32 v131, v131, v131
    v_and_b32 v131, 0xffff0000, v131
    v_sqrt_f32 v131, v131
    s_nop 0
    v_cvt_pk_bf16_f32 v131, v131, v131
    v_and_b32 v131, 0xffff0000, v131
    v_rcp_f32 v133, v131
    s_nop 0
    s_lshl_b32 s21, s20, 7
    v_lshl_add_u32 v130, v127, 2, s21
    s_lshl_b32 s21, s37, 7
    v_lshl_add_u32 v131, v127, 2, s21
    v_add_u32 v130, 161536, v130
    v_add_u32 v131, 161536, v131
    ds_write2_b32 v130, v132, v133 offset1:128
    ds_write_b32 v131, v134 offset:1024
    s_waitcnt lgkmcnt(0)
    s_barrier
    buffer_load_dword v3, off, s[16:19], 0 sc1
    v_xor_b32 v128, 128, v131
    ds_read_b32 v135, v128 offset:1024
    s_lshl_b32 s21, s20, 7
    v_lshl_add_u32 v129, v126, 4, s21
    v_add_u32 v129, 161536, v129
    v_xor_b32 v131, 128, v129
    ds_read_b128 v[68:71], v129 offset:0
    ds_read_b128 v[72:75], v129 offset:32
    ds_read_b128 v[76:79], v129 offset:64
    ds_read_b128 v[80:83], v129 offset:96
    ds_read_b128 v[84:87], v129 offset:512
    ds_read_b128 v[88:91], v129 offset:544
    ds_read_b128 v[92:95], v129 offset:576
    ds_read_b128 v[96:99], v129 offset:608
    s_waitcnt lgkmcnt(0)
    v_pk_fma_f32 v[4:5], v[68:69], v[134:135], v[4:5] op_sel:[0,0,0] op_sel_hi:[1,0,1]
    v_pk_fma_f32 v[6:7], v[70:71], v[134:135], v[6:7] op_sel:[0,0,0] op_sel_hi:[1,0,1]
    v_pk_fma_f32 v[8:9], v[72:73], v[134:135], v[8:9] op_sel:[0,0,0] op_sel_hi:[1,0,1]
    v_pk_fma_f32 v[10:11], v[74:75], v[134:135], v[10:11] op_sel:[0,0,0] op_sel_hi:[1,0,1]
    v_pk_fma_f32 v[12:13], v[76:77], v[134:135], v[12:13] op_sel:[0,0,0] op_sel_hi:[1,0,1]
    v_pk_fma_f32 v[14:15], v[78:79], v[134:135], v[14:15] op_sel:[0,0,0] op_sel_hi:[1,0,1]
    v_pk_fma_f32 v[16:17], v[80:81], v[134:135], v[16:17] op_sel:[0,0,0] op_sel_hi:[1,0,1]
    v_pk_fma_f32 v[18:19], v[82:83], v[134:135], v[18:19] op_sel:[0,0,0] op_sel_hi:[1,0,1]
    v_pk_mul_f32 v[4:5], v[4:5], v[84:85] op_sel:[0,0] op_sel_hi:[1,1]
    v_pk_mul_f32 v[6:7], v[6:7], v[86:87] op_sel:[0,0] op_sel_hi:[1,1]
    v_pk_mul_f32 v[8:9], v[8:9], v[88:89] op_sel:[0,0] op_sel_hi:[1,1]
    v_pk_mul_f32 v[10:11], v[10:11], v[90:91] op_sel:[0,0] op_sel_hi:[1,1]
    v_pk_mul_f32 v[12:13], v[12:13], v[92:93] op_sel:[0,0] op_sel_hi:[1,1]
    v_pk_mul_f32 v[14:15], v[14:15], v[94:95] op_sel:[0,0] op_sel_hi:[1,1]
    v_pk_mul_f32 v[16:17], v[16:17], v[96:97] op_sel:[0,0] op_sel_hi:[1,1]
    v_pk_mul_f32 v[18:19], v[18:19], v[98:99] op_sel:[0,0] op_sel_hi:[1,1]
    v_cvt_pk_bf16_f32 v4, v4, v5
    v_cvt_pk_bf16_f32 v5, v6, v7
    v_cvt_pk_bf16_f32 v6, v8, v9
    v_cvt_pk_bf16_f32 v7, v10, v11
    buffer_store_dwordx4 v[4:7], v136, s[12:15], s38 offen sc1
    v_cvt_pk_bf16_f32 v12, v12, v13
    v_cvt_pk_bf16_f32 v13, v14, v15
    v_cvt_pk_bf16_f32 v14, v16, v17
    v_cvt_pk_bf16_f32 v15, v18, v19
    s_add_u32 s21, s38, 20480
    buffer_store_dwordx4 v[12:15], v136, s[12:15], s21 offen sc1
    v_pk_fma_f32 v[20:21], v[68:69], v[134:135], v[20:21] op_sel:[0,1,0] op_sel_hi:[1,1,1]
    v_pk_fma_f32 v[22:23], v[70:71], v[134:135], v[22:23] op_sel:[0,1,0] op_sel_hi:[1,1,1]
    v_pk_fma_f32 v[24:25], v[72:73], v[134:135], v[24:25] op_sel:[0,1,0] op_sel_hi:[1,1,1]
    v_pk_fma_f32 v[26:27], v[74:75], v[134:135], v[26:27] op_sel:[0,1,0] op_sel_hi:[1,1,1]
    v_pk_fma_f32 v[28:29], v[76:77], v[134:135], v[28:29] op_sel:[0,1,0] op_sel_hi:[1,1,1]
    v_pk_fma_f32 v[30:31], v[78:79], v[134:135], v[30:31] op_sel:[0,1,0] op_sel_hi:[1,1,1]
    v_pk_fma_f32 v[32:33], v[80:81], v[134:135], v[32:33] op_sel:[0,1,0] op_sel_hi:[1,1,1]
    v_pk_fma_f32 v[34:35], v[82:83], v[134:135], v[34:35] op_sel:[0,1,0] op_sel_hi:[1,1,1]
    v_pk_mul_f32 v[20:21], v[20:21], v[84:85] op_sel:[0,0] op_sel_hi:[1,1]
    v_pk_mul_f32 v[22:23], v[22:23], v[86:87] op_sel:[0,0] op_sel_hi:[1,1]
    v_pk_mul_f32 v[24:25], v[24:25], v[88:89] op_sel:[0,0] op_sel_hi:[1,1]
    v_pk_mul_f32 v[26:27], v[26:27], v[90:91] op_sel:[0,0] op_sel_hi:[1,1]
    v_pk_mul_f32 v[28:29], v[28:29], v[92:93] op_sel:[0,0] op_sel_hi:[1,1]
    v_pk_mul_f32 v[30:31], v[30:31], v[94:95] op_sel:[0,0] op_sel_hi:[1,1]
    v_pk_mul_f32 v[32:33], v[32:33], v[96:97] op_sel:[0,0] op_sel_hi:[1,1]
    v_pk_mul_f32 v[34:35], v[34:35], v[98:99] op_sel:[0,0] op_sel_hi:[1,1]
    v_cvt_pk_bf16_f32 v20, v20, v21
    v_cvt_pk_bf16_f32 v21, v22, v23
    v_cvt_pk_bf16_f32 v22, v24, v25
    v_cvt_pk_bf16_f32 v23, v26, v27
    buffer_store_dwordx4 v[20:23], v137, s[12:15], s38 offen sc1
    v_cvt_pk_bf16_f32 v28, v28, v29
    v_cvt_pk_bf16_f32 v29, v30, v31
    v_cvt_pk_bf16_f32 v30, v32, v33
    v_cvt_pk_bf16_f32 v31, v34, v35
    s_add_u32 s21, s38, 20480
    buffer_store_dwordx4 v[28:31], v137, s[12:15], s21 offen sc1
    ds_read_b128 v[68:71], v131 offset:0
    ds_read_b128 v[72:75], v131 offset:32
    ds_read_b128 v[76:79], v131 offset:64
    ds_read_b128 v[80:83], v131 offset:96
    ds_read_b128 v[84:87], v131 offset:512
    ds_read_b128 v[88:91], v131 offset:544
    ds_read_b128 v[92:95], v131 offset:576
    ds_read_b128 v[96:99], v131 offset:608
    s_waitcnt lgkmcnt(0)
    v_pk_fma_f32 v[36:37], v[68:69], v[134:135], v[36:37] op_sel:[0,0,0] op_sel_hi:[1,0,1]
    v_pk_fma_f32 v[38:39], v[70:71], v[134:135], v[38:39] op_sel:[0,0,0] op_sel_hi:[1,0,1]
    v_pk_fma_f32 v[40:41], v[72:73], v[134:135], v[40:41] op_sel:[0,0,0] op_sel_hi:[1,0,1]
    v_pk_fma_f32 v[42:43], v[74:75], v[134:135], v[42:43] op_sel:[0,0,0] op_sel_hi:[1,0,1]
    v_pk_fma_f32 v[44:45], v[76:77], v[134:135], v[44:45] op_sel:[0,0,0] op_sel_hi:[1,0,1]
    v_pk_fma_f32 v[46:47], v[78:79], v[134:135], v[46:47] op_sel:[0,0,0] op_sel_hi:[1,0,1]
    v_pk_fma_f32 v[48:49], v[80:81], v[134:135], v[48:49] op_sel:[0,0,0] op_sel_hi:[1,0,1]
    v_pk_fma_f32 v[50:51], v[82:83], v[134:135], v[50:51] op_sel:[0,0,0] op_sel_hi:[1,0,1]
    v_pk_mul_f32 v[36:37], v[36:37], v[84:85] op_sel:[0,0] op_sel_hi:[1,1]
    v_pk_mul_f32 v[38:39], v[38:39], v[86:87] op_sel:[0,0] op_sel_hi:[1,1]
    v_pk_mul_f32 v[40:41], v[40:41], v[88:89] op_sel:[0,0] op_sel_hi:[1,1]
    v_pk_mul_f32 v[42:43], v[42:43], v[90:91] op_sel:[0,0] op_sel_hi:[1,1]
    v_pk_mul_f32 v[44:45], v[44:45], v[92:93] op_sel:[0,0] op_sel_hi:[1,1]
    v_pk_mul_f32 v[46:47], v[46:47], v[94:95] op_sel:[0,0] op_sel_hi:[1,1]
    v_pk_mul_f32 v[48:49], v[48:49], v[96:97] op_sel:[0,0] op_sel_hi:[1,1]
    v_pk_mul_f32 v[50:51], v[50:51], v[98:99] op_sel:[0,0] op_sel_hi:[1,1]
    v_cvt_pk_bf16_f32 v36, v36, v37
    v_cvt_pk_bf16_f32 v37, v38, v39
    v_cvt_pk_bf16_f32 v38, v40, v41
    v_cvt_pk_bf16_f32 v39, v42, v43
    buffer_store_dwordx4 v[36:39], v136, s[12:15], s39 offen sc1
    v_cvt_pk_bf16_f32 v44, v44, v45
    v_cvt_pk_bf16_f32 v45, v46, v47
    v_cvt_pk_bf16_f32 v46, v48, v49
    v_cvt_pk_bf16_f32 v47, v50, v51
    s_add_u32 s21, s39, 20480
    buffer_store_dwordx4 v[44:47], v136, s[12:15], s21 offen sc1
    v_pk_fma_f32 v[52:53], v[68:69], v[134:135], v[52:53] op_sel:[0,1,0] op_sel_hi:[1,1,1]
    v_pk_fma_f32 v[54:55], v[70:71], v[134:135], v[54:55] op_sel:[0,1,0] op_sel_hi:[1,1,1]
    v_pk_fma_f32 v[56:57], v[72:73], v[134:135], v[56:57] op_sel:[0,1,0] op_sel_hi:[1,1,1]
    v_pk_fma_f32 v[58:59], v[74:75], v[134:135], v[58:59] op_sel:[0,1,0] op_sel_hi:[1,1,1]
    v_pk_fma_f32 v[60:61], v[76:77], v[134:135], v[60:61] op_sel:[0,1,0] op_sel_hi:[1,1,1]
    v_pk_fma_f32 v[62:63], v[78:79], v[134:135], v[62:63] op_sel:[0,1,0] op_sel_hi:[1,1,1]
    v_pk_fma_f32 v[64:65], v[80:81], v[134:135], v[64:65] op_sel:[0,1,0] op_sel_hi:[1,1,1]
    v_pk_fma_f32 v[66:67], v[82:83], v[134:135], v[66:67] op_sel:[0,1,0] op_sel_hi:[1,1,1]
    v_pk_mul_f32 v[52:53], v[52:53], v[84:85] op_sel:[0,0] op_sel_hi:[1,1]
    v_pk_mul_f32 v[54:55], v[54:55], v[86:87] op_sel:[0,0] op_sel_hi:[1,1]
    v_pk_mul_f32 v[56:57], v[56:57], v[88:89] op_sel:[0,0] op_sel_hi:[1,1]
    v_pk_mul_f32 v[58:59], v[58:59], v[90:91] op_sel:[0,0] op_sel_hi:[1,1]
    v_pk_mul_f32 v[60:61], v[60:61], v[92:93] op_sel:[0,0] op_sel_hi:[1,1]
    v_pk_mul_f32 v[62:63], v[62:63], v[94:95] op_sel:[0,0] op_sel_hi:[1,1]
    v_pk_mul_f32 v[64:65], v[64:65], v[96:97] op_sel:[0,0] op_sel_hi:[1,1]
    v_pk_mul_f32 v[66:67], v[66:67], v[98:99] op_sel:[0,0] op_sel_hi:[1,1]
    v_cvt_pk_bf16_f32 v52, v52, v53
    v_cvt_pk_bf16_f32 v53, v54, v55
    v_cvt_pk_bf16_f32 v54, v56, v57
    v_cvt_pk_bf16_f32 v55, v58, v59
    buffer_store_dwordx4 v[52:55], v137, s[12:15], s39 offen sc1
    v_cvt_pk_bf16_f32 v60, v60, v61
    v_cvt_pk_bf16_f32 v61, v62, v63
    v_cvt_pk_bf16_f32 v62, v64, v65
    v_cvt_pk_bf16_f32 v63, v66, v67
    s_add_u32 s21, s39, 20480
    buffer_store_dwordx4 v[60:63], v137, s[12:15], s21 offen sc1
L_att_pre:
    v_lshlrev_b32 v2, 4, v1
    s_lshl_b32 s24, s2, 7
    s_add_u32 s24, s24, 26345472
    s_mov_b32 s14, 0x1930000
    s_mov_b32 s15, 0x20000
    s_mov_b32 s18, 256
    s_mov_b32 s19, 0x20000
    s_waitcnt lgkmcnt(0)
    s_mov_b64 s[12:13], s[10:11]
    s_mov_b64 s[16:17], s[8:9]
    s_and_b32 s25, s2, 7
    s_lshl_b32 s25, s25, 2
    s_bfe_u32 s21, s2, 0x20003
    s_add_u32 s25, s25, s21
    s_lshr_b32 s26, s2, 5
    s_and_b32 s27, s2, 1
    s_lshl_b32 s27, s27, 3
    s_bfe_u32 s21, s2, 0x30003
    s_add_u32 s27, s27, s21
    s_bfe_u32 s28, s2, 0x20001
    s_lshl_b32 s28, s28, 2
    s_lshr_b32 s21, s2, 6
    s_add_u32 s28, s28, s21
    s_and_b32 s31, s2, 7
    s_lshl_b32 s31, s31, 2
    s_bfe_u32 s21, s2, 0x20003
    s_add_u32 s31, s31, s21
    s_lshr_b32 s33, s20, 2
    s_lshr_b32 s32, s2, 5
    s_lshl_b32 s32, s32, 2
    s_and_b32 s21, s20, 3
    s_add_u32 s32, s32, s21
    s_lshl_b32 s32, s32, 1
    s_add_u32 s32, s32, s33
    v_and_b32 v161, 0x33, v1
    v_and_b32 v162, 4, v1
    v_lshl_or_b32 v161, v162, 1, v161
    v_bfe_u32 v162, v1, 3, 1
    v_lshl_or_b32 v161, v162, 2, v161
    v_and_b32 v161, 31, v161
    v_lshlrev_b32 v155, 4, v161
    v_lshrrev_b32 v162, 5, v1
    v_mul_u32_u24 v164, 32768, v162
    v_add_u32 v154, v155, v164
    v_and_b32 v161, 31, v1
    v_lshl_add_u32 v164, v161, 4, v164
    v_mul_u32_u24 v162, 10240, v162
    v_lshl_add_u32 v156, v161, 4, v162
    v_add_u32 v157, 20480, v156
    s_lshl_b32 s21, s33, 9
    v_xor_b32 v163, s21, v2
    s_mov_b32 s42, 0x000fffff
    s_mov_b32 s43, 0x000fffff
    s_mov_b32 s38, 0
    s_lshr_b32 s21, s31, 1
    s_mul_i32 s21, s21, 163840
    s_and_b32 s22, s31, 1
    s_mul_i32 s39, s22, 98304
    s_add_u32 s39, s39, s21
    s_lshl3_add_u32 s40, s22, s21
    s_add_u32 s40, s40, 65536
    s_lshl_b32 s21, s32, 9
    s_add_u32 s44, s39, s21
    s_xor_b32 s21, s21, 512
    s_add_u32 s46, s39, s21
    s_lshr_b32 s21, s32, 1
    s_lshl_b32 s21, s21, 10
    s_add_u32 s45, s21, s40
    s_andn2_b32 s21, s40, 8
    s_min_u32 s21, s21, s39
    s_sub_u32 s39, s39, s21
    s_sub_u32 s40, s40, s21
    v_add_u32 v154, s39, v154
    v_add_u32 v155, s40, v155
    s_add_u32 s39, s21, 2621440
    s_add_u32 s40, s39, 32256
    s_mul_i32 s41, s31, 320
    s_add_u32 s41, s41, 5242880
    s_add_u32 s35, s41, 2580480
    s_lshl_b32 s21, s33, 14
    s_add_u32 s34, s39, s21
    s_mul_i32 s21, s33, 1310720
    s_add_u32 s36, s41, s21
    v_cmp_eq_u32 vcc, 20, v161
    v_mov_b32 v162, 0x3f803f80
    v_mov_b32 v158, 0xdddddddd
    v_cndmask_b32 v116, 0, v162, vcc
    v_cndmask_b32 v117, 0, v162, vcc
    v_cndmask_b32 v118, 0, v162, vcc
    v_cndmask_b32 v119, 0, v162, vcc
    v_cndmask_b32 v120, 0, v162, vcc
    v_cndmask_b32 v121, 0, v162, vcc
    v_cndmask_b32 v122, 0, v162, vcc
    v_cndmask_b32 v123, 0, v162, vcc
    v_cndmask_b32 v124, 0, v162, vcc
    v_cndmask_b32 v125, 0, v162, vcc
    v_cndmask_b32 v126, 0, v162, vcc
    v_cndmask_b32 v127, 0, v162, vcc
    v_cndmask_b32 v128, 0, v162, vcc
    v_cndmask_b32 v129, 0, v162, vcc
    v_cndmask_b32 v130, 0, v162, vcc
    v_cndmask_b32 v131, 0, v162, vcc
    v_cndmask_b32 v132, 0, v162, vcc
    v_cndmask_b32 v133, 0, v162, vcc
    v_cndmask_b32 v134, 0, v162, vcc
    v_cndmask_b32 v135, 0, v162, vcc
    v_cndmask_b32 v136, 0, v162, vcc
    v_cndmask_b32 v137, 0, v162, vcc
    v_cndmask_b32 v138, 0, v162, vcc
    v_cndmask_b32 v139, 0, v162, vcc
    v_cndmask_b32 v140, 0, v162, vcc
    v_cndmask_b32 v141, 0, v162, vcc
    v_cndmask_b32 v142, 0, v162, vcc
    v_cndmask_b32 v143, 0, v162, vcc
    v_cndmask_b32 v144, 0, v162, vcc
    v_cndmask_b32 v145, 0, v162, vcc
    v_cndmask_b32 v146, 0, v162, vcc
    v_cndmask_b32 v147, 0, v162, vcc
    s_cmp_eq_u32 s20, 4
    s_cbranch_scc1 L_q_poll
    s_cmp_gt_u32 s20, 4
    s_cbranch_scc1 L_q_wait
    s_cmp_ge_u32 s30, 15
    s_cbranch_scc1 L_q_wait
    s_mul_i32 s21, s30, 52
    s_lshr_b32 s21, s21, 8
    s_mul_i32 s21, s21, 5
    s_sub_u32 s21, s30, s21
    s_cmp_eq_u32 s21, 2
    s_cselect_b32 s22, 64, 56
    s_mul_i32 s21, s21, 51
    s_lshr_b32 s21, s21, 3
    v_lshrrev_b32 v36, 3, v1
    v_add_u32 v36, s21, v36
    v_and_b32 v37, 7, v1
    v_lshrrev_b32 v39, 2, v36
    v_and_b32 v36, 3, v36
    v_lshl_add_u32 v39, v36, 3, v39
    v_lshl_add_u32 v39, v37, 5, v39
    v_lshlrev_b32 v39, 7, v39
    v_cmp_gt_u32 s[4:5], s22, v1
    s_lshr_b32 s21, s29, 1
    v_cmp_eq_u32 vcc, s21, v37
    s_cmp_lt_u32 s30, 5
    s_cselect_b64 vcc, vcc, -1
    s_cselect_b32 s23, 0, 0
    s_and_b64 s[4:5], s[4:5], vcc
    s_add_u32 s23, s23, 26345472
    v_mov_b32 v36, 163596
    v_mov_b32 v37, 1
    s_mov_b64 exec, 1
    s_waitcnt vmcnt(0)
    ds_add_rtn_u32 v38, v36, v37
    s_waitcnt lgkmcnt(0)
    v_readfirstlane_b32 s21, v38
    s_cmp_eq_u32 s21, 3
    s_cbranch_scc0 L_q_wait
    s_mov_b32 s21, 16384
L_kf_fus_ini_7:
    v_cmp_ne_u32 vcc, 16, v3
    s_sub_u32 s21, s21, 1
    s_cbranch_vccz L_kf_fus_inid_8
    s_cbranch_scc1 L_kf_fus_inid_8
    s_sleep 8
    buffer_load_dword v3, off, s[16:19], 0 sc1
    s_waitcnt vmcnt(0)
    s_branch L_kf_fus_ini_7
L_kf_fus_inid_8:
    s_mov_b64 exec, s[4:5]
    buffer_atomic_add v37, v39, s[12:15], s23 offen offset:16 sc1
L_q_wait:
    s_mov_b64 exec, -1
    s_barrier
    s_branch L_q_go
L_q_poll:
    s_mov_b64 exec, 1
    buffer_load_dword v3, off, s[16:19], 0 sc1
    s_waitcnt vmcnt(0)
    s_mov_b32 s21, 16384
L_kf_fus_ini_9:
    v_cmp_ne_u32 vcc, 16, v3
    s_sub_u32 s21, s21, 1
    s_cbranch_vccz L_kf_fus_inid_10
    s_cbranch_scc1 L_kf_fus_inid_10
    s_sleep 8
    buffer_load_dword v3, off, s[16:19], 0 sc1
    s_waitcnt vmcnt(0)
    s_branch L_kf_fus_ini_9
L_kf_fus_inid_10:
    s_bitcmp1_b32 0x02081040, s31
    s_cselect_b32 s22, 68, 34
    s_mov_b32 s21, 16384
    v_mov_b32 v36, 163600
    v_mov_b32 v37, 1
L_q_pl:
    s_sleep 0
    buffer_load_dword v38, off, s[12:15], s24 offset:16 sc1
    s_sub_u32 s21, s21, 1
    s_waitcnt vmcnt(0)
    v_cmp_ne_u32 vcc, s22, v38
    s_cbranch_scc1 L_q_pd
    s_cbranch_vccnz L_q_pl
L_q_pd:
    s_barrier
    s_mov_b64 exec, -1
L_q_go:
    buffer_load_dwordx2 v[148:149], v163, s[12:15], s45 offen
    buffer_load_dwordx4 v[100:103], v164, s[12:15], s44 offen
    buffer_load_dwordx4 v[104:107], v164, s[12:15], s46 offen
    buffer_load_dwordx2 v[150:151], v155, s[12:15], s34 offen
    buffer_load_dwordx4 v[108:111], v154, s[12:15], s34 offen
    s_add_u32 s34, s34, 512
    s_min_u32 s34, s34, s40
    v_mov_b32 v68, 0
    v_mov_b32 v69, 0
    v_mov_b32 v70, 0
    v_mov_b32 v71, 0
    v_mov_b32 v72, 0
    v_mov_b32 v73, 0
    v_mov_b32 v74, 0
    v_mov_b32 v75, 0
    v_mov_b32 v76, 0
    v_mov_b32 v77, 0
    v_mov_b32 v78, 0
    v_mov_b32 v79, 0
    v_mov_b32 v80, 0
    v_mov_b32 v81, 0
    v_mov_b32 v82, 0
    v_mov_b32 v83, 0
    v_mov_b32 v84, 0
    v_mov_b32 v85, 0
    v_mov_b32 v86, 0
    v_mov_b32 v87, 0
    v_mov_b32 v88, 0
    v_mov_b32 v89, 0
    v_mov_b32 v90, 0
    v_mov_b32 v91, 0
    v_mov_b32 v92, 0
    v_mov_b32 v93, 0
    v_mov_b32 v94, 0
    v_mov_b32 v95, 0
    v_mov_b32 v96, 0
    v_mov_b32 v97, 0
    v_mov_b32 v98, 0
    v_mov_b32 v99, 0
    buffer_load_dwordx2 v[152:153], v155, s[12:15], s34 offen
    buffer_load_dwordx4 v[112:115], v154, s[12:15], s34 offen
    s_add_u32 s34, s34, 512
    s_min_u32 s34, s34, s40
    s_mov_b64 exec, s[42:43]
    buffer_load_dwordx4 v[116:119], v156, s[12:15], s36 offen
    buffer_load_dwordx4 v[120:123], v157, s[12:15], s36 offen
    s_mov_b64 exec, -1
    s_add_u32 s36, s36, 40960
    s_min_u32 s36, s36, s35
    s_waitcnt vmcnt(5)
    v_mfma_f32_32x32x4_2b_bf16 v[4:35], v[150:151], v[148:149], 0
    s_nop 15
    s_waitcnt vmcnt(4)
    s_nop 3
    v_mfma_f32_32x32x16_bf16 v[4:19], v[108:111], v[100:103], v[4:19]
    v_mfma_f32_32x32x16_bf16 v[20:35], v[108:111], v[104:107], v[20:35]
    v_mov_b32 v60, 0
    v_mov_b32 v61, 0
    v_mov_b32 v62, 0
    v_mov_b32 v63, 0
    v_mov_b32 v64, 0
    v_mov_b32 v65, 0
    v_mov_b32 v66, 0
    v_mov_b32 v67, 0
    s_mov_b64 exec, s[42:43]
    buffer_load_dwordx4 v[124:127], v156, s[12:15], s36 offen
    buffer_load_dwordx4 v[128:131], v157, s[12:15], s36 offen
    s_mov_b64 exec, -1
    s_add_u32 s36, s36, 40960
    s_min_u32 s36, s36, s35
    s_mov_b64 exec, s[42:43]
    buffer_load_dwordx4 v[132:135], v156, s[12:15], s36 offen
    buffer_load_dwordx4 v[136:139], v157, s[12:15], s36 offen
    s_mov_b64 exec, -1
    s_add_u32 s36, s36, 40960
    s_min_u32 s36, s36, s35
    buffer_load_dwordx2 v[150:151], v155, s[12:15], s34 offen
    buffer_load_dwordx4 v[108:111], v154, s[12:15], s34 offen
    s_add_u32 s34, s34, 512
    s_min_u32 s34, s34, s40
    s_mov_b32 s37, 16
    s_nop 1
    s_setprio 3
    s_mov_b32 s47, 8
    .p2align 6
L_k2_loop:
    v_exp_f32 v4, v4
    v_exp_f32 v5, v5
    v_smfmac_f32_32x32x32_bf16 v[84:99], v[144:147], v[60:67], v158
    s_mov_b64 exec, s[42:43]
    buffer_load_dwordx4 v[140:143], v156, s[12:15], s36 offen
    buffer_load_dwordx4 v[144:147], v157, s[12:15], s36 offen
    s_mov_b64 exec, -1
    s_add_u32 s36, s36, 40960
    s_min_u32 s36, s36, s35
    v_exp_f32 v6, v6
    v_exp_f32 v7, v7
    v_exp_f32 v8, v8
    v_exp_f32 v9, v9
    s_waitcnt vmcnt(7)
    v_mfma_f32_32x32x4_2b_bf16 v[36:67], v[152:153], v[148:149], 0
    v_exp_f32 v10, v10
    v_exp_f32 v11, v11
    v_exp_f32 v12, v12
    buffer_load_dwordx2 v[152:153], v155, s[12:15], s34 offen
    v_exp_f32 v13, v13
    v_exp_f32 v14, v14
    v_exp_f32 v15, v15
    v_exp_f32 v16, v16
    v_exp_f32 v17, v17
    v_smfmac_f32_32x32x32_bf16 v[68:83], v[116:119], v[4:11], v158
    v_exp_f32 v18, v18
    v_exp_f32 v19, v19
    v_exp_f32 v20, v20
    v_exp_f32 v21, v21
    v_smfmac_f32_32x32x32_bf16 v[68:83], v[120:123], v[12:19], v158
    v_exp_f32 v22, v22
    v_exp_f32 v23, v23
    v_exp_f32 v24, v24
    v_exp_f32 v25, v25
    s_waitcnt vmcnt(7)
    v_mfma_f32_32x32x16_bf16 v[36:51], v[112:115], v[100:103], v[36:51]
    v_exp_f32 v26, v26
    v_exp_f32 v27, v27
    v_exp_f32 v28, v28
    v_exp_f32 v29, v29
    v_mfma_f32_32x32x16_bf16 v[52:67], v[112:115], v[104:107], v[52:67]
    buffer_load_dwordx4 v[112:115], v154, s[12:15], s34 offen
    s_add_u32 s34, s34, 512
    s_min_u32 s34, s34, s40
    v_exp_f32 v30, v30
    v_exp_f32 v31, v31
    v_exp_f32 v32, v32
    v_exp_f32 v33, v33
    v_smfmac_f32_32x32x32_bf16 v[84:99], v[116:119], v[20:27], v158
    v_exp_f32 v34, v34
    v_exp_f32 v35, v35
    v_exp_f32 v36, v36
    v_exp_f32 v37, v37
    v_smfmac_f32_32x32x32_bf16 v[84:99], v[120:123], v[28:35], v158
    s_mov_b64 exec, s[42:43]
    buffer_load_dwordx4 v[116:119], v156, s[12:15], s36 offen
    buffer_load_dwordx4 v[120:123], v157, s[12:15], s36 offen
    s_mov_b64 exec, -1
    s_add_u32 s36, s36, 40960
    s_min_u32 s36, s36, s35
    v_exp_f32 v38, v38
    v_exp_f32 v39, v39
    v_exp_f32 v40, v40
    v_exp_f32 v41, v41
    s_waitcnt vmcnt(7)
    v_mfma_f32_32x32x4_2b_bf16 v[4:35], v[150:151], v[148:149], 0
    v_exp_f32 v42, v42
    v_exp_f32 v43, v43
    v_exp_f32 v44, v44
    buffer_load_dwordx2 v[150:151], v155, s[12:15], s34 offen
    v_exp_f32 v45, v45
    v_exp_f32 v46, v46
    v_exp_f32 v47, v47
    v_exp_f32 v48, v48
    v_exp_f32 v49, v49
    v_smfmac_f32_32x32x32_bf16 v[68:83], v[124:127], v[36:43], v158
    v_exp_f32 v50, v50
    v_exp_f32 v51, v51
    v_exp_f32 v52, v52
    v_exp_f32 v53, v53
    v_smfmac_f32_32x32x32_bf16 v[68:83], v[128:131], v[44:51], v158
    v_exp_f32 v54, v54
    v_exp_f32 v55, v55
    v_exp_f32 v56, v56
    v_exp_f32 v57, v57
    s_waitcnt vmcnt(7)
    v_mfma_f32_32x32x16_bf16 v[4:19], v[108:111], v[100:103], v[4:19]
    v_exp_f32 v58, v58
    v_exp_f32 v59, v59
    v_exp_f32 v60, v60
    v_exp_f32 v61, v61
    v_mfma_f32_32x32x16_bf16 v[20:35], v[108:111], v[104:107], v[20:35]
    buffer_load_dwordx4 v[108:111], v154, s[12:15], s34 offen
    s_add_u32 s34, s34, 512
    s_min_u32 s34, s34, s40
    v_exp_f32 v62, v62
    v_exp_f32 v63, v63
    v_exp_f32 v64, v64
    v_exp_f32 v65, v65
    v_smfmac_f32_32x32x32_bf16 v[84:99], v[124:127], v[52:59], v158
    v_exp_f32 v66, v66
    v_exp_f32 v67, v67
    v_exp_f32 v4, v4
    v_exp_f32 v5, v5
    v_smfmac_f32_32x32x32_bf16 v[84:99], v[128:131], v[60:67], v158
    s_mov_b64 exec, s[42:43]
    buffer_load_dwordx4 v[124:127], v156, s[12:15], s36 offen
    buffer_load_dwordx4 v[128:131], v157, s[12:15], s36 offen
    s_mov_b64 exec, -1
    s_add_u32 s36, s36, 40960
    s_min_u32 s36, s36, s35
    v_exp_f32 v6, v6
    v_exp_f32 v7, v7
    v_exp_f32 v8, v8
    v_exp_f32 v9, v9
    s_waitcnt vmcnt(7)
    v_mfma_f32_32x32x4_2b_bf16 v[36:67], v[152:153], v[148:149], 0
    v_exp_f32 v10, v10
    v_exp_f32 v11, v11
    v_exp_f32 v12, v12
    buffer_load_dwordx2 v[152:153], v155, s[12:15], s34 offen
    v_exp_f32 v13, v13
    v_exp_f32 v14, v14
    v_exp_f32 v15, v15
    v_exp_f32 v16, v16
    v_exp_f32 v17, v17
    v_smfmac_f32_32x32x32_bf16 v[68:83], v[132:135], v[4:11], v158
    v_exp_f32 v18, v18
    v_exp_f32 v19, v19
    v_exp_f32 v20, v20
    v_exp_f32 v21, v21
    v_smfmac_f32_32x32x32_bf16 v[68:83], v[136:139], v[12:19], v158
    v_exp_f32 v22, v22
    v_exp_f32 v23, v23
    v_exp_f32 v24, v24
    v_exp_f32 v25, v25
    s_waitcnt vmcnt(7)
    v_mfma_f32_32x32x16_bf16 v[36:51], v[112:115], v[100:103], v[36:51]
    v_exp_f32 v26, v26
    v_exp_f32 v27, v27
    v_exp_f32 v28, v28
    v_exp_f32 v29, v29
    v_mfma_f32_32x32x16_bf16 v[52:67], v[112:115], v[104:107], v[52:67]
    buffer_load_dwordx4 v[112:115], v154, s[12:15], s34 offen
    s_add_u32 s34, s34, 512
    s_min_u32 s34, s34, s40
    v_exp_f32 v30, v30
    v_exp_f32 v31, v31
    v_exp_f32 v32, v32
    v_exp_f32 v33, v33
    v_smfmac_f32_32x32x32_bf16 v[84:99], v[132:135], v[20:27], v158
    v_exp_f32 v34, v34
    v_exp_f32 v35, v35
    v_exp_f32 v36, v36
    v_exp_f32 v37, v37
    v_smfmac_f32_32x32x32_bf16 v[84:99], v[136:139], v[28:35], v158
    s_mov_b64 exec, s[42:43]
    buffer_load_dwordx4 v[132:135], v156, s[12:15], s36 offen
    buffer_load_dwordx4 v[136:139], v157, s[12:15], s36 offen
    s_mov_b64 exec, -1
    s_add_u32 s36, s36, 40960
    s_min_u32 s36, s36, s35
    v_exp_f32 v38, v38
    v_exp_f32 v39, v39
    v_exp_f32 v40, v40
    v_exp_f32 v41, v41
    s_waitcnt vmcnt(7)
    v_mfma_f32_32x32x4_2b_bf16 v[4:35], v[150:151], v[148:149], 0
    v_exp_f32 v42, v42
    v_exp_f32 v43, v43
    v_exp_f32 v44, v44
    buffer_load_dwordx2 v[150:151], v155, s[12:15], s34 offen
    v_exp_f32 v45, v45
    s_sub_u32 s37, s37, 2
    v_exp_f32 v46, v46
    v_exp_f32 v47, v47
    v_exp_f32 v48, v48
    v_exp_f32 v49, v49
    v_smfmac_f32_32x32x32_bf16 v[68:83], v[140:143], v[36:43], v158
    v_exp_f32 v50, v50
    v_exp_f32 v51, v51
    v_exp_f32 v52, v52
    v_exp_f32 v53, v53
    v_smfmac_f32_32x32x32_bf16 v[68:83], v[144:147], v[44:51], v158
    v_exp_f32 v54, v54
    v_exp_f32 v55, v55
    v_exp_f32 v56, v56
    v_exp_f32 v57, v57
    s_waitcnt vmcnt(7)
    v_mfma_f32_32x32x16_bf16 v[4:19], v[108:111], v[100:103], v[4:19]
    v_exp_f32 v58, v58
    v_exp_f32 v59, v59
    v_exp_f32 v60, v60
    v_exp_f32 v61, v61
    v_mfma_f32_32x32x16_bf16 v[20:35], v[108:111], v[104:107], v[20:35]
    buffer_load_dwordx4 v[108:111], v154, s[12:15], s34 offen
    s_add_u32 s34, s34, 512
    s_min_u32 s34, s34, s40
    v_exp_f32 v62, v62
    v_exp_f32 v63, v63
    s_cmp_lg_u32 s37, s47
    v_exp_f32 v64, v64
    v_exp_f32 v65, v65
    v_smfmac_f32_32x32x32_bf16 v[84:99], v[140:143], v[52:59], v158
    v_exp_f32 v66, v66
    v_exp_f32 v67, v67
    s_cbranch_scc1 L_k2_loop
    s_cmp_eq_u32 s37, 0
    s_cbranch_scc1 L_k2_done
    s_cmp_eq_u32 s37, 8
    s_cbranch_scc0 L_k2_p1
    s_setprio 2
    s_mov_b32 s47, 4
    s_branch L_k2_loop
L_k2_p1:
    s_cmp_eq_u32 s37, 4
    s_cbranch_scc0 L_k2_p0
    s_setprio 1
    s_mov_b32 s47, 2
    s_branch L_k2_loop
L_k2_p0:
    s_setprio 0
    s_mov_b32 s47, 0
    s_branch L_k2_loop
L_k2_done:
    s_nop 1
    v_smfmac_f32_32x32x32_bf16 v[84:99], v[144:147], v[60:67], v158
    s_mul_i32 s21, s20, 3072
    v_add_u32 v163, s21, v2
    s_xor_b32 s22, s20, 4
    s_mul_i32 s22, s22, 3072
    v_add_u32 v164, s22, v2
    v_add_f32 v161, |v68|, |v69|
    v_add_f32 v161, v161, |v70|
    v_add_f32 v161, v161, |v71|
    v_add_f32 v161, v161, |v72|
    v_add_f32 v161, v161, |v73|
    v_add_f32 v161, v161, |v74|
    v_add_f32 v161, v161, |v75|
    v_add_f32 v161, v161, |v76|
    v_add_f32 v161, v161, |v77|
    v_add_f32 v161, v161, |v78|
    v_add_f32 v161, v161, |v79|
    ds_write_b128 v163, v[84:87] offset:24576
    ds_write_b128 v163, v[88:91] offset:25600
    ds_write_b128 v163, v[92:95] offset:26624
    v_add_f32 v161, v161, |v84|
    v_add_f32 v161, v161, |v85|
    v_add_f32 v161, v161, |v86|
    v_add_f32 v161, v161, |v87|
    v_add_f32 v161, v161, |v88|
    v_add_f32 v161, v161, |v89|
    v_add_f32 v161, v161, |v90|
    v_add_f32 v161, v161, |v91|
    v_add_f32 v161, v161, |v92|
    v_add_f32 v161, v161, |v93|
    v_add_f32 v161, v161, |v94|
    v_add_f32 v161, v161, |v95|
    s_mov_b32 s21, 0x5d000000
    v_cmp_ngt_f32 vcc, s21, v161
    v_min_f32 v161, v76, v92
    s_or_b32 s21, vcc_lo, vcc_hi
    s_mov_b32 s3, 0x2b800000
    v_cmp_nlt_f32 vcc, s3, v161
    s_lshl_b32 s22, s20, 2
    s_add_u32 s22, s22, 163648
    v_mov_b32 v162, s22
    s_or_b32 s21, s21, vcc_hi
    v_mov_b32 v161, s21
    ds_write_b32 v162, v161
    v_and_b32 v162, 28, v1
    v_add_u32 v162, 163648, v162
    s_waitcnt lgkmcnt(0)
    s_barrier
    ds_read_b32 v161, v162
    ds_read_b128 v[4:7], v164 offset:24576
    ds_read_b128 v[8:11], v164 offset:25600
    ds_read_b128 v[12:15], v164 offset:26624
    s_mul_i32 s21, s32, 40960
    s_add_u32 s21, s21, 7864320
    s_lshl_b32 s22, s31, 9
    s_add_u32 s22, s22, s21
    v_bfe_u32 v162, v1, 4, 1
    v_mul_u32_u24 v162, 20480, v162
    v_and_b32 v163, 15, v1
    v_lshl_add_u32 v162, v163, 4, v162
    v_lshrrev_b32 v163, 5, v1
    v_lshl_add_u32 v163, v163, 8, v162
    s_lshr_b32 s3, s31, 1
    s_lshl_b32 s3, s3, 8
    s_add_u32 s21, s21, s3
    s_and_b32 s3, s31, 1
    s_lshl_b32 s3, s3, 3
    s_add_u32 s21, s21, s3
    s_add_u32 s21, s21, 16384
    s_waitcnt lgkmcnt(3)
    v_cmp_ne_u32 vcc, 0, v161
    s_cmp_lg_u32 s38, 0
    s_cbranch_scc1 L_k2_fin
    s_cbranch_vccnz L_k2_fb
L_k2_fin:
    s_waitcnt vmcnt(0) lgkmcnt(0)
    v_add_f32 v76, v76, v12
    v_pk_add_f32 v[68:69], v[68:69], v[4:5] op_sel:[0,0] op_sel_hi:[1,1]
    v_pk_add_f32 v[70:71], v[70:71], v[6:7] op_sel:[0,0] op_sel_hi:[1,1]
    v_pk_add_f32 v[72:73], v[72:73], v[8:9] op_sel:[0,0] op_sel_hi:[1,1]
    v_pk_add_f32 v[74:75], v[74:75], v[10:11] op_sel:[0,0] op_sel_hi:[1,1]
    v_pk_add_f32 v[78:79], v[78:79], v[14:15] op_sel:[0,0] op_sel_hi:[1,1]
    v_rcp_f32 v161, v76
    v_add_f32 v77, v77, v13
    s_nop 0
    v_mov_b32 v4, v161
    v_mov_b32 v5, v161
    s_nop 1
    v_permlane32_swap_b32 v4, v5
    s_nop 1
    v_pk_mul_f32 v[68:69], v[68:69], v[4:5] op_sel:[0,1] op_sel_hi:[1,1]
    v_pk_mul_f32 v[70:71], v[70:71], v[4:5] op_sel:[0,1] op_sel_hi:[1,1]
    v_pk_mul_f32 v[72:73], v[72:73], v[4:5] op_sel:[0,1] op_sel_hi:[1,1]
    v_pk_mul_f32 v[74:75], v[74:75], v[4:5] op_sel:[0,1] op_sel_hi:[1,1]
    v_pk_mul_f32 v[76:77], v[76:77], v[4:5] op_sel:[0,1] op_sel_hi:[1,1]
    v_pk_mul_f32 v[78:79], v[78:79], v[4:5] op_sel:[0,1] op_sel_hi:[1,1]
    v_cvt_pk_bf16_f32 v68, v68, v69
    v_cvt_pk_bf16_f32 v69, v70, v71
    v_cvt_pk_bf16_f32 v70, v72, v73
    v_cvt_pk_bf16_f32 v71, v74, v75
    v_cvt_pk_bf16_f32 v72, v76, v77
    v_cvt_pk_bf16_f32 v73, v78, v79
    buffer_store_dwordx4 v[68:71], v163, s[12:15], s22 offen sc1
    s_mov_b32 exec_hi, 0
    buffer_store_dwordx2 v[72:73], v162, s[12:15], s21 offen sc1
    s_mov_b64 exec, -1
    s_cmp_ge_u32 s20, 4
    s_cbranch_scc1 L_f_load
    s_load_dwordx2 s[32:33], s[0:1], 0
    s_lshl_b32 s36, s25, 2
    s_add_u32 s36, s36, s20
    s_and_b32 s22, s20, 1
    s_lshl_b32 s21, s22, 10
    s_add_u32 s21, s21, 7864320
    s_mul_i32 s34, s36, 20480
    s_add_u32 s34, s34, s21
    s_xor_b32 s35, s36, 1
    s_mul_i32 s35, s35, 20480
    s_add_u32 s35, s35, s21
    s_mul_i32 s3, s22, 5120
    v_and_b32 v64, 15, v1
    v_lshrrev_b32 v65, 4, v1
    s_lshl_b32 s21, s36, 4
    v_add_u32 v66, s21, v64
    v_mul_u32_u24 v67, 1280, v66
    s_mul_i32 s21, s26, 160
    v_add_u32 v67, s21, v67
    v_lshl_add_u32 v158, v65, 4, v67
    v_lshl_add_u32 v160, v65, 3, v67
    s_lshr_b32 s21, s36, 1
    s_mul_i32 s21, s21, 40960
    s_and_b32 s22, s36, 1
    s_lshl_b32 s22, s22, 8
    s_add_u32 s21, s21, s22
    s_mul_i32 s22, s26, 5120
    s_add_u32 s21, s21, s22
    s_add_u32 s21, s21, 17203200
    v_lshl_add_u32 v64, v64, 4, s21
    v_lshl_add_u32 v159, v65, 9, v64
    v_lshrrev_b32 v68, 1, v65
    v_lshl_add_u32 v64, v68, 9, v64
    v_and_b32 v65, 1, v65
    v_lshl_add_u32 v64, v65, 3, v64
    v_add_u32 v161, 4096, v64
    s_waitcnt lgkmcnt(0)
    s_mov_b32 s40, s32
    s_mov_b32 s41, s33
    s_mov_b32 s42, 0x280000
    s_mov_b32 s43, 0x20000
    buffer_load_dwordx4 v[148:151], v158, s[40:43], 0 offen
    buffer_load_dwordx4 v[152:155], v158, s[40:43], 0 offen offset:64
    buffer_load_dwordx2 v[156:157], v160, s[40:43], 0 offen offset:128
    v_add_u32 v162, s3, v2
    v_add_u32 v163, 120576, v162
    v_add_u32 v162, 59136, v162
    s_lshr_b32 s23, s2, 5
    v_lshlrev_b32 v75, 10, v1
    s_lshl_b32 s23, s23, 7
    s_add_u32 s23, s23, 26345472
    v_mov_b32 v72, 163584
    v_mov_b32 v73, 1
    s_mov_b64 exec, 1
    s_waitcnt vmcnt(3)
    ds_add_rtn_u32 v74, v72, v73
    s_waitcnt lgkmcnt(0)
    v_readfirstlane_b32 s21, v74
    s_cmp_eq_u32 s21, 0
    s_cbranch_scc1 L_kf_fus_poll_12_0
    s_cmp_eq_u32 s21, 7
    s_cbranch_scc0 L_kf_fus_go_11
    s_mov_b32 exec_lo, 0xffffffff
    buffer_atomic_add v73, v75, s[12:15], s23 offen offset:0 sc1
    s_branch L_kf_fus_go_11
L_kf_fus_poll_12_0:
    s_mov_b32 s21, 16384
L_kf_fus_poll_12:
    buffer_load_dword v74, off, s[12:15], s24 offset:0 sc1
    s_sub_u32 s21, s21, 1
    s_waitcnt vmcnt(0)
    v_cmp_ne_u32 vcc, 32, v74
    s_cmp_eq_u32 s21, 0
    s_cbranch_scc1 L_kf_fus_go_11
    s_cbranch_vccnz L_kf_fus_poll_12
L_kf_fus_go_11:
    s_mov_b64 exec, -1
    s_barrier
    buffer_load_dwordx4 v[88:91], v2, s[12:15], s35 offen offset:0 sc1
    buffer_load_dwordx4 v[84:87], v2, s[12:15], s34 offen offset:0 sc1
    buffer_load_dwordx4 v[96:99], v2, s[12:15], s35 offen offset:2048 sc1
    s_add_u32 s35, s35, 4096
    buffer_load_dwordx4 v[92:95], v2, s[12:15], s34 offen offset:2048 sc1
    s_add_u32 s34, s34, 4096
    buffer_load_dwordx4 v[104:107], v2, s[12:15], s35 offen offset:0 sc1
    buffer_load_dwordx4 v[100:103], v2, s[12:15], s34 offen offset:0 sc1
    buffer_load_dwordx4 v[112:115], v2, s[12:15], s35 offen offset:2048 sc1
    s_add_u32 s35, s35, 4096
    buffer_load_dwordx4 v[108:111], v2, s[12:15], s34 offen offset:2048 sc1
    s_add_u32 s34, s34, 4096
    buffer_load_dwordx4 v[120:123], v2, s[12:15], s35 offen offset:0 sc1
    buffer_load_dwordx4 v[116:119], v2, s[12:15], s34 offen offset:0 sc1
    buffer_load_dwordx4 v[128:131], v2, s[12:15], s35 offen offset:2048 sc1
    s_add_u32 s35, s35, 4096
    buffer_load_dwordx4 v[124:127], v2, s[12:15], s34 offen offset:2048 sc1
    s_add_u32 s34, s34, 4096
    buffer_load_dwordx4 v[136:139], v2, s[12:15], s35 offen offset:0 sc1
    buffer_load_dwordx4 v[132:135], v2, s[12:15], s34 offen offset:0 sc1
    buffer_load_dwordx4 v[144:147], v2, s[12:15], s35 offen offset:2048 sc1
    s_add_u32 s35, s35, 4096
    buffer_load_dwordx4 v[140:143], v2, s[12:15], s34 offen offset:2048 sc1
    s_add_u32 s34, s34, 4096
    ds_read_b128 v[44:47], v162 offset:0
    ds_read_b128 v[48:51], v162 offset:1024
    ds_read_b128 v[52:55], v162 offset:2048
    ds_read_b128 v[56:59], v162 offset:3072
    ds_read_b128 v[60:63], v162 offset:4096
    s_waitcnt vmcnt(15) lgkmcnt(0)
    v_mfma_f32_16x16x32_bf16 v[24:27], v[44:47], v[88:91], 0
    ds_read_b128 v[64:67], v162 offset:10240
    v_mfma_f32_16x16x32_bf16 v[28:31], v[48:51], v[88:91], 0
    ds_read_b128 v[68:71], v162 offset:11264
    v_mfma_f32_16x16x32_bf16 v[32:35], v[52:55], v[88:91], 0
    ds_read_b128 v[72:75], v162 offset:12288
    v_mfma_f32_16x16x32_bf16 v[36:39], v[56:59], v[88:91], 0
    ds_read_b128 v[76:79], v162 offset:13312
    v_mfma_f32_16x16x32_bf16 v[40:43], v[60:63], v[88:91], 0
    ds_read_b128 v[80:83], v162 offset:14336
    s_waitcnt vmcnt(14)
    v_mfma_f32_16x16x32_bf16 v[4:7], v[44:47], v[84:87], 0
    v_mfma_f32_16x16x32_bf16 v[8:11], v[48:51], v[84:87], 0
    v_mfma_f32_16x16x32_bf16 v[12:15], v[52:55], v[84:87], 0
    v_mfma_f32_16x16x32_bf16 v[16:19], v[56:59], v[84:87], 0
    v_mfma_f32_16x16x32_bf16 v[20:23], v[60:63], v[84:87], 0
    s_waitcnt vmcnt(13) lgkmcnt(0)
    v_mfma_f32_16x16x32_bf16 v[24:27], v[64:67], v[96:99], v[24:27]
    ds_read_b128 v[44:47], v162 offset:20480
    v_mfma_f32_16x16x32_bf16 v[28:31], v[68:71], v[96:99], v[28:31]
    ds_read_b128 v[48:51], v162 offset:21504
    v_mfma_f32_16x16x32_bf16 v[32:35], v[72:75], v[96:99], v[32:35]
    ds_read_b128 v[52:55], v162 offset:22528
    v_mfma_f32_16x16x32_bf16 v[36:39], v[76:79], v[96:99], v[36:39]
    ds_read_b128 v[56:59], v162 offset:23552
    v_mfma_f32_16x16x32_bf16 v[40:43], v[80:83], v[96:99], v[40:43]
    ds_read_b128 v[60:63], v162 offset:24576
    s_waitcnt vmcnt(12)
    v_mfma_f32_16x16x32_bf16 v[4:7], v[64:67], v[92:95], v[4:7]
    buffer_load_dwordx4 v[88:91], v2, s[12:15], s35 offen offset:0 sc1
    v_mfma_f32_16x16x32_bf16 v[8:11], v[68:71], v[92:95], v[8:11]
    v_mfma_f32_16x16x32_bf16 v[12:15], v[72:75], v[92:95], v[12:15]
    buffer_load_dwordx4 v[84:87], v2, s[12:15], s34 offen offset:0 sc1
    v_mfma_f32_16x16x32_bf16 v[16:19], v[76:79], v[92:95], v[16:19]
    v_mfma_f32_16x16x32_bf16 v[20:23], v[80:83], v[92:95], v[20:23]
    s_waitcnt vmcnt(13) lgkmcnt(0)
    v_mfma_f32_16x16x32_bf16 v[24:27], v[44:47], v[104:107], v[24:27]
    ds_read_b128 v[64:67], v162 offset:30720
    v_mfma_f32_16x16x32_bf16 v[28:31], v[48:51], v[104:107], v[28:31]
    ds_read_b128 v[68:71], v162 offset:31744
    v_mfma_f32_16x16x32_bf16 v[32:35], v[52:55], v[104:107], v[32:35]
    ds_read_b128 v[72:75], v162 offset:32768
    v_mfma_f32_16x16x32_bf16 v[36:39], v[56:59], v[104:107], v[36:39]
    ds_read_b128 v[76:79], v162 offset:33792
    v_mfma_f32_16x16x32_bf16 v[40:43], v[60:63], v[104:107], v[40:43]
    ds_read_b128 v[80:83], v162 offset:34816
    s_waitcnt vmcnt(12)
    v_mfma_f32_16x16x32_bf16 v[4:7], v[44:47], v[100:103], v[4:7]
    buffer_load_dwordx4 v[96:99], v2, s[12:15], s35 offen offset:2048 sc1
    v_mfma_f32_16x16x32_bf16 v[8:11], v[48:51], v[100:103], v[8:11]
    v_mfma_f32_16x16x32_bf16 v[12:15], v[52:55], v[100:103], v[12:15]
    buffer_load_dwordx4 v[92:95], v2, s[12:15], s34 offen offset:2048 sc1
    v_mfma_f32_16x16x32_bf16 v[16:19], v[56:59], v[100:103], v[16:19]
    v_mfma_f32_16x16x32_bf16 v[20:23], v[60:63], v[100:103], v[20:23]
    s_waitcnt vmcnt(13) lgkmcnt(0)
    v_mfma_f32_16x16x32_bf16 v[24:27], v[64:67], v[112:115], v[24:27]
    ds_read_b128 v[44:47], v162 offset:40960
    v_mfma_f32_16x16x32_bf16 v[28:31], v[68:71], v[112:115], v[28:31]
    ds_read_b128 v[48:51], v162 offset:41984
    v_mfma_f32_16x16x32_bf16 v[32:35], v[72:75], v[112:115], v[32:35]
    ds_read_b128 v[52:55], v162 offset:43008
    v_mfma_f32_16x16x32_bf16 v[36:39], v[76:79], v[112:115], v[36:39]
    ds_read_b128 v[56:59], v162 offset:44032
    v_mfma_f32_16x16x32_bf16 v[40:43], v[80:83], v[112:115], v[40:43]
    ds_read_b128 v[60:63], v162 offset:45056
    s_waitcnt vmcnt(12)
    v_mfma_f32_16x16x32_bf16 v[4:7], v[64:67], v[108:111], v[4:7]
    v_mfma_f32_16x16x32_bf16 v[8:11], v[68:71], v[108:111], v[8:11]
    v_mfma_f32_16x16x32_bf16 v[12:15], v[72:75], v[108:111], v[12:15]
    v_mfma_f32_16x16x32_bf16 v[16:19], v[76:79], v[108:111], v[16:19]
    v_mfma_f32_16x16x32_bf16 v[20:23], v[80:83], v[108:111], v[20:23]
    s_waitcnt vmcnt(11) lgkmcnt(0)
    v_mfma_f32_16x16x32_bf16 v[24:27], v[44:47], v[120:123], v[24:27]
    ds_read_b128 v[64:67], v162 offset:51200
    v_mfma_f32_16x16x32_bf16 v[28:31], v[48:51], v[120:123], v[28:31]
    ds_read_b128 v[68:71], v162 offset:52224
    v_mfma_f32_16x16x32_bf16 v[32:35], v[52:55], v[120:123], v[32:35]
    ds_read_b128 v[72:75], v162 offset:53248
    v_mfma_f32_16x16x32_bf16 v[36:39], v[56:59], v[120:123], v[36:39]
    ds_read_b128 v[76:79], v162 offset:54272
    v_mfma_f32_16x16x32_bf16 v[40:43], v[60:63], v[120:123], v[40:43]
    ds_read_b128 v[80:83], v162 offset:55296
    s_waitcnt vmcnt(10)
    v_mfma_f32_16x16x32_bf16 v[4:7], v[44:47], v[116:119], v[4:7]
    v_mfma_f32_16x16x32_bf16 v[8:11], v[48:51], v[116:119], v[8:11]
    v_mfma_f32_16x16x32_bf16 v[12:15], v[52:55], v[116:119], v[12:15]
    v_mfma_f32_16x16x32_bf16 v[16:19], v[56:59], v[116:119], v[16:19]
    v_mfma_f32_16x16x32_bf16 v[20:23], v[60:63], v[116:119], v[20:23]
    s_waitcnt vmcnt(9) lgkmcnt(0)
    v_mfma_f32_16x16x32_bf16 v[24:27], v[64:67], v[128:131], v[24:27]
    ds_read_b128 v[44:47], v163 offset:0
    v_mfma_f32_16x16x32_bf16 v[28:31], v[68:71], v[128:131], v[28:31]
    ds_read_b128 v[48:51], v163 offset:1024
    v_mfma_f32_16x16x32_bf16 v[32:35], v[72:75], v[128:131], v[32:35]
    ds_read_b128 v[52:55], v163 offset:2048
    v_mfma_f32_16x16x32_bf16 v[36:39], v[76:79], v[128:131], v[36:39]
    ds_read_b128 v[56:59], v163 offset:3072
    v_mfma_f32_16x16x32_bf16 v[40:43], v[80:83], v[128:131], v[40:43]
    ds_read_b128 v[60:63], v163 offset:4096
    s_waitcnt vmcnt(8)
    v_mfma_f32_16x16x32_bf16 v[4:7], v[64:67], v[124:127], v[4:7]
    v_mfma_f32_16x16x32_bf16 v[8:11], v[68:71], v[124:127], v[8:11]
    v_mfma_f32_16x16x32_bf16 v[12:15], v[72:75], v[124:127], v[12:15]
    v_mfma_f32_16x16x32_bf16 v[16:19], v[76:79], v[124:127], v[16:19]
    v_mfma_f32_16x16x32_bf16 v[20:23], v[80:83], v[124:127], v[20:23]
    s_waitcnt vmcnt(7) lgkmcnt(0)
    v_mfma_f32_16x16x32_bf16 v[24:27], v[44:47], v[136:139], v[24:27]
    ds_read_b128 v[64:67], v163 offset:10240
    v_mfma_f32_16x16x32_bf16 v[28:31], v[48:51], v[136:139], v[28:31]
    ds_read_b128 v[68:71], v163 offset:11264
    v_mfma_f32_16x16x32_bf16 v[32:35], v[52:55], v[136:139], v[32:35]
    ds_read_b128 v[72:75], v163 offset:12288
    v_mfma_f32_16x16x32_bf16 v[36:39], v[56:59], v[136:139], v[36:39]
    ds_read_b128 v[76:79], v163 offset:13312
    v_mfma_f32_16x16x32_bf16 v[40:43], v[60:63], v[136:139], v[40:43]
    ds_read_b128 v[80:83], v163 offset:14336
    s_waitcnt vmcnt(6)
    v_mfma_f32_16x16x32_bf16 v[4:7], v[44:47], v[132:135], v[4:7]
    v_mfma_f32_16x16x32_bf16 v[8:11], v[48:51], v[132:135], v[8:11]
    v_mfma_f32_16x16x32_bf16 v[12:15], v[52:55], v[132:135], v[12:15]
    v_mfma_f32_16x16x32_bf16 v[16:19], v[56:59], v[132:135], v[16:19]
    v_mfma_f32_16x16x32_bf16 v[20:23], v[60:63], v[132:135], v[20:23]
    s_waitcnt vmcnt(5) lgkmcnt(0)
    v_mfma_f32_16x16x32_bf16 v[24:27], v[64:67], v[144:147], v[24:27]
    ds_read_b128 v[44:47], v163 offset:20480
    v_mfma_f32_16x16x32_bf16 v[28:31], v[68:71], v[144:147], v[28:31]
    ds_read_b128 v[48:51], v163 offset:21504
    v_mfma_f32_16x16x32_bf16 v[32:35], v[72:75], v[144:147], v[32:35]
    ds_read_b128 v[52:55], v163 offset:22528
    v_mfma_f32_16x16x32_bf16 v[36:39], v[76:79], v[144:147], v[36:39]
    ds_read_b128 v[56:59], v163 offset:23552
    v_mfma_f32_16x16x32_bf16 v[40:43], v[80:83], v[144:147], v[40:43]
    ds_read_b128 v[60:63], v163 offset:24576
    s_waitcnt vmcnt(4)
    v_mfma_f32_16x16x32_bf16 v[4:7], v[64:67], v[140:143], v[4:7]
    v_mfma_f32_16x16x32_bf16 v[8:11], v[68:71], v[140:143], v[8:11]
    v_mfma_f32_16x16x32_bf16 v[12:15], v[72:75], v[140:143], v[12:15]
    v_mfma_f32_16x16x32_bf16 v[16:19], v[76:79], v[140:143], v[16:19]
    v_mfma_f32_16x16x32_bf16 v[20:23], v[80:83], v[140:143], v[20:23]
    s_waitcnt vmcnt(3) lgkmcnt(0)
    v_mfma_f32_16x16x32_bf16 v[24:27], v[44:47], v[88:91], v[24:27]
    ds_read_b128 v[64:67], v163 offset:30720
    v_mfma_f32_16x16x32_bf16 v[28:31], v[48:51], v[88:91], v[28:31]
    ds_read_b128 v[68:71], v163 offset:31744
    v_mfma_f32_16x16x32_bf16 v[32:35], v[52:55], v[88:91], v[32:35]
    ds_read_b128 v[72:75], v163 offset:32768
    v_mfma_f32_16x16x32_bf16 v[36:39], v[56:59], v[88:91], v[36:39]
    ds_read_b128 v[76:79], v163 offset:33792
    v_mfma_f32_16x16x32_bf16 v[40:43], v[60:63], v[88:91], v[40:43]
    ds_read_b128 v[80:83], v163 offset:34816
    s_waitcnt vmcnt(2)
    v_mfma_f32_16x16x32_bf16 v[4:7], v[44:47], v[84:87], v[4:7]
    v_mfma_f32_16x16x32_bf16 v[8:11], v[48:51], v[84:87], v[8:11]
    v_mfma_f32_16x16x32_bf16 v[12:15], v[52:55], v[84:87], v[12:15]
    v_mfma_f32_16x16x32_bf16 v[16:19], v[56:59], v[84:87], v[16:19]
    v_mfma_f32_16x16x32_bf16 v[20:23], v[60:63], v[84:87], v[20:23]
    s_waitcnt vmcnt(1) lgkmcnt(0)
    v_mfma_f32_16x16x32_bf16 v[24:27], v[64:67], v[96:99], v[24:27]
    v_mfma_f32_16x16x32_bf16 v[28:31], v[68:71], v[96:99], v[28:31]
    v_mfma_f32_16x16x32_bf16 v[32:35], v[72:75], v[96:99], v[32:35]
    v_mfma_f32_16x16x32_bf16 v[36:39], v[76:79], v[96:99], v[36:39]
    v_mfma_f32_16x16x32_bf16 v[40:43], v[80:83], v[96:99], v[40:43]
    s_waitcnt vmcnt(0)
    v_mfma_f32_16x16x32_bf16 v[4:7], v[64:67], v[92:95], v[4:7]
    v_mfma_f32_16x16x32_bf16 v[8:11], v[68:71], v[92:95], v[8:11]
    v_mfma_f32_16x16x32_bf16 v[12:15], v[72:75], v[92:95], v[12:15]
    v_mfma_f32_16x16x32_bf16 v[16:19], v[76:79], v[92:95], v[16:19]
    v_mfma_f32_16x16x32_bf16 v[20:23], v[80:83], v[92:95], v[20:23]
    s_mul_i32 s21, s20, 5120
    s_add_u32 s21, s21, 24576
    v_add_u32 v162, s21, v2
    s_xor_b32 s21, s20, 1
    s_mul_i32 s21, s21, 5120
    s_add_u32 s21, s21, 24576
    v_add_u32 v163, s21, v2
    ds_write_b128 v162, v[24:27] offset:0
    ds_write_b128 v162, v[28:31] offset:1024
    ds_write_b128 v162, v[32:35] offset:2048
    ds_write_b128 v162, v[36:39] offset:3072
    ds_write_b128 v162, v[40:43] offset:4096
    v_lshlrev_b32 v44, 16, v148
    v_and_b32 v45, 0xffff0000, v148
    v_lshlrev_b32 v46, 16, v149
    v_and_b32 v47, 0xffff0000, v149
    v_lshlrev_b32 v48, 16, v150
    v_and_b32 v49, 0xffff0000, v150
    v_lshlrev_b32 v50, 16, v151
    v_and_b32 v51, 0xffff0000, v151
    v_lshlrev_b32 v52, 16, v152
    v_and_b32 v53, 0xffff0000, v152
    v_lshlrev_b32 v54, 16, v153
    v_and_b32 v55, 0xffff0000, v153
    v_lshlrev_b32 v56, 16, v154
    v_and_b32 v57, 0xffff0000, v154
    v_lshlrev_b32 v58, 16, v155
    v_and_b32 v59, 0xffff0000, v155
    v_lshlrev_b32 v60, 16, v156
    v_and_b32 v61, 0xffff0000, v156
    v_lshlrev_b32 v62, 16, v157
    v_and_b32 v63, 0xffff0000, v157
    v_pk_add_f32 v[44:45], v[44:45], v[4:5] op_sel:[0,0] op_sel_hi:[1,1]
    v_pk_add_f32 v[46:47], v[46:47], v[6:7] op_sel:[0,0] op_sel_hi:[1,1]
    v_pk_add_f32 v[48:49], v[48:49], v[8:9] op_sel:[0,0] op_sel_hi:[1,1]
    v_pk_add_f32 v[50:51], v[50:51], v[10:11] op_sel:[0,0] op_sel_hi:[1,1]
    v_pk_add_f32 v[52:53], v[52:53], v[12:13] op_sel:[0,0] op_sel_hi:[1,1]
    v_pk_add_f32 v[54:55], v[54:55], v[14:15] op_sel:[0,0] op_sel_hi:[1,1]
    v_pk_add_f32 v[56:57], v[56:57], v[16:17] op_sel:[0,0] op_sel_hi:[1,1]
    v_pk_add_f32 v[58:59], v[58:59], v[18:19] op_sel:[0,0] op_sel_hi:[1,1]
    v_pk_add_f32 v[60:61], v[60:61], v[20:21] op_sel:[0,0] op_sel_hi:[1,1]
    v_pk_add_f32 v[62:63], v[62:63], v[22:23] op_sel:[0,0] op_sel_hi:[1,1]
    s_waitcnt lgkmcnt(0)
    s_barrier
    ds_read_b128 v[24:27], v163 offset:0
    ds_read_b128 v[28:31], v163 offset:1024
    ds_read_b128 v[32:35], v163 offset:2048
    ds_read_b128 v[36:39], v163 offset:3072
    ds_read_b128 v[40:43], v163 offset:4096
    s_waitcnt lgkmcnt(4)
    v_pk_add_f32 v[44:45], v[44:45], v[24:25] op_sel:[0,0] op_sel_hi:[1,1]
    v_pk_add_f32 v[46:47], v[46:47], v[26:27] op_sel:[0,0] op_sel_hi:[1,1]
    s_waitcnt lgkmcnt(3)
    v_pk_add_f32 v[48:49], v[48:49], v[28:29] op_sel:[0,0] op_sel_hi:[1,1]
    v_pk_add_f32 v[50:51], v[50:51], v[30:31] op_sel:[0,0] op_sel_hi:[1,1]
    s_waitcnt lgkmcnt(2)
    v_pk_add_f32 v[52:53], v[52:53], v[32:33] op_sel:[0,0] op_sel_hi:[1,1]
    v_pk_add_f32 v[54:55], v[54:55], v[34:35] op_sel:[0,0] op_sel_hi:[1,1]
    s_waitcnt lgkmcnt(1)
    v_pk_add_f32 v[56:57], v[56:57], v[36:37] op_sel:[0,0] op_sel_hi:[1,1]
    v_pk_add_f32 v[58:59], v[58:59], v[38:39] op_sel:[0,0] op_sel_hi:[1,1]
    s_waitcnt lgkmcnt(0)
    v_pk_add_f32 v[60:61], v[60:61], v[40:41] op_sel:[0,0] op_sel_hi:[1,1]
    v_pk_add_f32 v[62:63], v[62:63], v[42:43] op_sel:[0,0] op_sel_hi:[1,1]
    v_cvt_pk_bf16_f32 v148, v44, v45
    v_cvt_pk_bf16_f32 v149, v46, v47
    v_cvt_pk_bf16_f32 v150, v48, v49
    v_cvt_pk_bf16_f32 v151, v50, v51
    v_cvt_pk_bf16_f32 v152, v52, v53
    v_cvt_pk_bf16_f32 v153, v54, v55
    v_cvt_pk_bf16_f32 v154, v56, v57
    v_cvt_pk_bf16_f32 v155, v58, v59
    v_cvt_pk_bf16_f32 v156, v60, v61
    v_cvt_pk_bf16_f32 v157, v62, v63
    buffer_store_dwordx4 v[148:151], v159, s[12:15], 0 offen sc1
    buffer_store_dwordx4 v[152:155], v159, s[12:15], 0 offen offset:2048 sc1
    buffer_store_dwordx2 v[156:157], v161, s[12:15], 0 offen sc1
    s_mov_b32 s22, 0x3f803f80
    v_mov_b32 v68, 0
    v_mov_b32 v69, 0
    v_dot2c_f32_bf16 v68, s22, v148
    v_dot2c_f32_bf16 v69, v148, v148
    v_dot2c_f32_bf16 v68, s22, v149
    v_dot2c_f32_bf16 v69, v149, v149
    v_dot2c_f32_bf16 v68, s22, v150
    v_dot2c_f32_bf16 v69, v150, v150
    v_dot2c_f32_bf16 v68, s22, v151
    v_dot2c_f32_bf16 v69, v151, v151
    v_dot2c_f32_bf16 v68, s22, v152
    v_dot2c_f32_bf16 v69, v152, v152
    v_dot2c_f32_bf16 v68, s22, v153
    v_dot2c_f32_bf16 v69, v153, v153
    v_dot2c_f32_bf16 v68, s22, v154
    v_dot2c_f32_bf16 v69, v154, v154
    v_dot2c_f32_bf16 v68, s22, v155
    v_dot2c_f32_bf16 v69, v155, v155
    v_dot2c_f32_bf16 v68, s22, v156
    v_dot2c_f32_bf16 v69, v156, v156
    v_dot2c_f32_bf16 v68, s22, v157
    v_dot2c_f32_bf16 v69, v157, v157
    s_lshl_b32 s21, s36, 10
    s_lshl_b32 s22, s26, 7
    s_add_u32 s21, s21, s22
    s_add_u32 s21, s21, 19824640
    v_permlane32_swap_b32 v68, v69
    v_and_b32 v64, 15, v1
    v_lshrrev_b32 v65, 5, v1
    v_add_f32 v68, v68, v69
    v_mov_b32 v69, v68
    v_lshlrev_b32 v64, 2, v64
    v_lshl_add_u32 v64, v65, 6, v64
    v_permlane16_swap_b32 v68, v69
    s_mov_b32 exec_lo, 0xffff
    s_mov_b32 exec_hi, 0xffff
    v_add_f32 v68, v68, v69
    buffer_store_dword v68, v64, s[12:15], s21 offen sc1
    s_mov_b64 exec, -1
    s_barrier
    s_lshr_b32 s31, s20, 1
    s_and_b32 s32, s20, 1
    v_and_b32 v152, 31, v1
    v_lshrrev_b32 v153, 5, v1
    s_lshl_b32 s21, s27, 1
    s_add_u32 s21, s21, s31
    s_mul_i32 s21, s21, 196608
    s_mul_i32 s22, s28, 3072
    s_add_u32 s21, s21, s22
    s_mul_i32 s22, s32, 1536
    s_add_u32 s21, s21, s22
    s_add_u32 s21, s21, 19955712
    v_lshrrev_b32 v154, 4, v152
    v_mul_u32_u24 v154, 49152, v154
    v_and_b32 v159, 15, v152
    v_lshl_add_u32 v154, v159, 4, v154
    v_lshl_add_u32 v154, v153, 8, v154
    v_add_u32 v159, s21, v154
    s_lshl_b32 s21, s31, 12
    s_add_u32 s21, s21, 122880
    v_add_u32 v157, s21, v2
    s_mul_i32 s21, s32, 3072
    v_add_u32 v158, s21, v2
    v_mov_b32 v155, v157
    v_mov_b32 v156, v158
    s_lshl_b32 s21, s31, 9
    s_add_u32 s21, s21, 162560
    v_lshl_add_u32 v152, v152, 3, s21
    s_mul_i32 s21, s32, 384
    s_add_u32 s21, s21, 161536
    v_lshl_add_u32 v153, v153, 4, s21
    s_mov_b32 s33, 0
    s_mov_b32 s34, 0
    s_mov_b32 s35, 20
    v_mov_b32 v4, 0
    v_mov_b32 v5, 0
    v_mov_b32 v6, 0
    v_mov_b32 v7, 0
    v_mov_b32 v8, 0
    v_mov_b32 v9, 0
    v_mov_b32 v10, 0
    v_mov_b32 v11, 0
    v_mov_b32 v12, 0
    v_mov_b32 v13, 0
    v_mov_b32 v14, 0
    v_mov_b32 v15, 0
    v_mov_b32 v16, 0
    v_mov_b32 v17, 0
    v_mov_b32 v18, 0
    v_mov_b32 v19, 0
    v_mov_b32 v20, 0
    v_mov_b32 v21, 0
    v_mov_b32 v22, 0
    v_mov_b32 v23, 0
    v_mov_b32 v24, 0
    v_mov_b32 v25, 0
    v_mov_b32 v26, 0
    v_mov_b32 v27, 0
    v_mov_b32 v28, 0
    v_mov_b32 v29, 0
    v_mov_b32 v30, 0
    v_mov_b32 v31, 0
    v_mov_b32 v32, 0
    v_mov_b32 v33, 0
    v_mov_b32 v34, 0
    v_mov_b32 v35, 0
    v_mov_b32 v36, 0
    v_mov_b32 v37, 0
    v_mov_b32 v38, 0
    v_mov_b32 v39, 0
    v_mov_b32 v40, 0
    v_mov_b32 v41, 0
    v_mov_b32 v42, 0
    v_mov_b32 v43, 0
    v_mov_b32 v44, 0
    v_mov_b32 v45, 0
    v_mov_b32 v46, 0
    v_mov_b32 v47, 0
    v_mov_b32 v48, 0
    v_mov_b32 v49, 0
    v_mov_b32 v50, 0
    v_mov_b32 v51, 0
    v_mov_b32 v52, 0
    v_mov_b32 v53, 0
    v_mov_b32 v54, 0
    v_mov_b32 v55, 0
    v_mov_b32 v56, 0
    v_mov_b32 v57, 0
    v_mov_b32 v58, 0
    v_mov_b32 v59, 0
    v_mov_b32 v60, 0
    v_mov_b32 v61, 0
    v_mov_b32 v62, 0
    v_mov_b32 v63, 0
    v_mov_b32 v64, 0
    v_mov_b32 v65, 0
    v_mov_b32 v66, 0
    v_mov_b32 v67, 0
    v_mov_b32 v68, 0
    v_mov_b32 v69, 0
    v_mov_b32 v70, 0
    v_mov_b32 v71, 0
    v_mov_b32 v72, 0
    v_mov_b32 v73, 0
    v_mov_b32 v74, 0
    v_mov_b32 v75, 0
    v_mov_b32 v76, 0
    v_mov_b32 v77, 0
    v_mov_b32 v78, 0
    v_mov_b32 v79, 0
    v_mov_b32 v80, 0
    v_mov_b32 v81, 0
    v_mov_b32 v82, 0
    v_mov_b32 v83, 0
    v_mov_b32 v84, 0
    v_mov_b32 v85, 0
    v_mov_b32 v86, 0
    v_mov_b32 v87, 0
    v_mov_b32 v88, 0
    v_mov_b32 v89, 0
    v_mov_b32 v90, 0
    v_mov_b32 v91, 0
    v_mov_b32 v92, 0
    v_mov_b32 v93, 0
    v_mov_b32 v94, 0
    v_mov_b32 v95, 0
    v_mov_b32 v96, 0
    v_mov_b32 v97, 0
    v_mov_b32 v98, 0
    v_mov_b32 v99, 0
    s_lshr_b32 s23, s25, 4
    s_bfe_u32 s21, s25, 0x30001
    s_lshl3_add_u32 s23, s21, s23
    v_and_b32 v143, 3, v1
    v_lshrrev_b32 v142, 2, v1
    v_lshlrev_b32 v143, 8, v143
    v_lshl_add_u32 v143, v142, 13, v143
    s_lshl_b32 s23, s23, 7
    s_add_u32 s23, s23, 26345472
    v_mov_b32 v140, 163588
    v_mov_b32 v141, 1
    s_mov_b64 exec, 1
    s_waitcnt vmcnt(0)
    ds_add_rtn_u32 v142, v140, v141
    s_waitcnt lgkmcnt(0)
    v_readfirstlane_b32 s21, v142
    s_cmp_eq_u32 s21, 0
    s_cbranch_scc1 L_kf_fus_poll_14_0
    s_cmp_eq_u32 s21, 3
    s_cbranch_scc0 L_kf_fus_go_13
    s_mov_b32 exec_lo, 0xffff
    buffer_atomic_add v141, v143, s[12:15], s23 offen offset:4 sc1
    s_branch L_kf_fus_go_13
L_kf_fus_poll_14_0:
    s_mov_b32 s21, 16384
L_kf_fus_poll_14:
    buffer_load_dword v142, off, s[12:15], s24 offset:4 sc1
    s_sub_u32 s21, s21, 1
    s_waitcnt vmcnt(0)
    v_cmp_ne_u32 vcc, 16, v142
    s_cmp_eq_u32 s21, 0
    s_cbranch_scc1 L_kf_fus_go_13
    s_cbranch_vccnz L_kf_fus_poll_14
L_kf_fus_go_13:
    s_mov_b64 exec, -1
    s_barrier
    s_barrier
    ds_read_b128 v[100:103], v155 offset:0
    ds_read_b128 v[116:119], v156 offset:0
    ds_read_b128 v[104:107], v155 offset:2048
    ds_read_b128 v[120:123], v156 offset:1024
    ds_read_b128 v[124:127], v156 offset:2048
    .p2align 6
L_kf_fus_loop_15:
    s_waitcnt lgkmcnt(0)
    v_mfma_f32_32x32x16_bf16 v[4:19], v[116:119], v[100:103], v[4:19]
    ds_read_b128 v[108:111], v155 offset:1024
    ds_read_b128 v[128:131], v156 offset:6144
    v_mfma_f32_32x32x16_bf16 v[52:67], v[116:119], v[104:107], v[52:67]
    ds_read_b128 v[112:115], v155 offset:3072
    ds_read_b128 v[132:135], v156 offset:7168
    v_mfma_f32_32x32x16_bf16 v[20:35], v[120:123], v[100:103], v[20:35]
    ds_read_b128 v[136:139], v156 offset:8192
    s_add_u32 s33, s33, 8192
    s_cmp_eq_u32 s33, 32768
    s_cselect_b32 s33, 0, s33
    v_mfma_f32_32x32x16_bf16 v[68:83], v[120:123], v[104:107], v[68:83]
    s_add_u32 s34, s34, 12288
    s_cmp_eq_u32 s34, 122880
    s_cselect_b32 s34, 0, s34
    s_sub_u32 s35, s35, 1
    v_mfma_f32_32x32x16_bf16 v[36:51], v[124:127], v[100:103], v[36:51]
    v_add_u32 v155, s33, v157
    v_add_u32 v156, s34, v158
    s_cmp_eq_u32 s35, 0
    v_mfma_f32_32x32x16_bf16 v[84:99], v[124:127], v[104:107], v[84:99]
    s_waitcnt lgkmcnt(0)
    s_cbranch_scc1 L_kf_fus_last_16
    s_barrier
    v_mfma_f32_32x32x16_bf16 v[4:19], v[128:131], v[108:111], v[4:19]
    ds_read_b128 v[100:103], v155 offset:0
    ds_read_b128 v[116:119], v156 offset:0
    v_mfma_f32_32x32x16_bf16 v[52:67], v[128:131], v[112:115], v[52:67]
    ds_read_b128 v[104:107], v155 offset:2048
    ds_read_b128 v[120:123], v156 offset:1024
    v_mfma_f32_32x32x16_bf16 v[20:35], v[132:135], v[108:111], v[20:35]
    ds_read_b128 v[124:127], v156 offset:2048
    v_mfma_f32_32x32x16_bf16 v[68:83], v[132:135], v[112:115], v[68:83]
    v_mfma_f32_32x32x16_bf16 v[36:51], v[136:139], v[108:111], v[36:51]
    v_mfma_f32_32x32x16_bf16 v[84:99], v[136:139], v[112:115], v[84:99]
    s_branch L_kf_fus_loop_15
L_kf_fus_last_16:
    v_mfma_f32_32x32x16_bf16 v[4:19], v[128:131], v[108:111], v[4:19]
    ds_read_b64 v[148:149], v152 offset:0
    ds_read_b64 v[150:151], v152 offset:256
    v_mfma_f32_32x32x16_bf16 v[52:67], v[128:131], v[112:115], v[52:67]
    v_mfma_f32_32x32x16_bf16 v[20:35], v[132:135], v[108:111], v[20:35]
    v_mfma_f32_32x32x16_bf16 v[68:83], v[132:135], v[112:115], v[68:83]
    v_mfma_f32_32x32x16_bf16 v[36:51], v[136:139], v[108:111], v[36:51]
    v_mfma_f32_32x32x16_bf16 v[84:99], v[136:139], v[112:115], v[84:99]
    s_nop 6
    s_mov_b32 s22, 98304
    ds_read_b128 v[100:103], v153 offset:0
    ds_read_b128 v[104:107], v153 offset:32
    ds_read_b128 v[108:111], v153 offset:64
    ds_read_b128 v[112:115], v153 offset:96
    ds_read_b128 v[116:119], v153 offset:128
    ds_read_b128 v[120:123], v153 offset:160
    ds_read_b128 v[124:127], v153 offset:192
    ds_read_b128 v[128:131], v153 offset:224
    ds_read_b128 v[132:135], v153 offset:256
    ds_read_b128 v[136:139], v153 offset:288
    ds_read_b128 v[140:143], v153 offset:320
    ds_read_b128 v[144:147], v153 offset:352
    s_waitcnt lgkmcnt(8)
    v_pk_fma_f32 v[4:5], v[100:101], v[148:149], v[4:5] op_sel:[0,0,0] op_sel_hi:[1,0,1]
    v_pk_fma_f32 v[6:7], v[102:103], v[148:149], v[6:7] op_sel:[0,0,0] op_sel_hi:[1,0,1]
    v_pk_fma_f32 v[8:9], v[104:105], v[148:149], v[8:9] op_sel:[0,0,0] op_sel_hi:[1,0,1]
    v_pk_fma_f32 v[10:11], v[106:107], v[148:149], v[10:11] op_sel:[0,0,0] op_sel_hi:[1,0,1]
    v_pk_fma_f32 v[12:13], v[108:109], v[148:149], v[12:13] op_sel:[0,0,0] op_sel_hi:[1,0,1]
    v_pk_fma_f32 v[14:15], v[110:111], v[148:149], v[14:15] op_sel:[0,0,0] op_sel_hi:[1,0,1]
    v_pk_fma_f32 v[16:17], v[112:113], v[148:149], v[16:17] op_sel:[0,0,0] op_sel_hi:[1,0,1]
    v_pk_fma_f32 v[18:19], v[114:115], v[148:149], v[18:19] op_sel:[0,0,0] op_sel_hi:[1,0,1]
    v_pk_mul_f32 v[4:5], v[4:5], v[148:149] op_sel:[0,1] op_sel_hi:[1,1]
    v_pk_mul_f32 v[6:7], v[6:7], v[148:149] op_sel:[0,1] op_sel_hi:[1,1]
    v_pk_mul_f32 v[12:13], v[12:13], v[148:149] op_sel:[0,1] op_sel_hi:[1,1]
    v_pk_mul_f32 v[14:15], v[14:15], v[148:149] op_sel:[0,1] op_sel_hi:[1,1]
    v_pk_mul_f32 v[4:5], v[4:5], v[8:9] op_sel:[0,0] op_sel_hi:[1,1]
    v_pk_mul_f32 v[6:7], v[6:7], v[10:11] op_sel:[0,0] op_sel_hi:[1,1]
    v_pk_mul_f32 v[12:13], v[12:13], v[16:17] op_sel:[0,0] op_sel_hi:[1,1]
    v_pk_mul_f32 v[14:15], v[14:15], v[18:19] op_sel:[0,0] op_sel_hi:[1,1]
    v_cvt_pk_bf16_f32 v8, v4, v5
    v_cvt_pk_bf16_f32 v9, v6, v7
    v_cvt_pk_bf16_f32 v10, v12, v13
    v_cvt_pk_bf16_f32 v11, v14, v15
    buffer_store_dwordx4 v[8:11], v159, s[12:15], 0 offen offset:0 sc1
    v_pk_fma_f32 v[52:53], v[100:101], v[150:151], v[52:53] op_sel:[0,0,0] op_sel_hi:[1,0,1]
    v_pk_fma_f32 v[54:55], v[102:103], v[150:151], v[54:55] op_sel:[0,0,0] op_sel_hi:[1,0,1]
    v_pk_fma_f32 v[56:57], v[104:105], v[150:151], v[56:57] op_sel:[0,0,0] op_sel_hi:[1,0,1]
    v_pk_fma_f32 v[58:59], v[106:107], v[150:151], v[58:59] op_sel:[0,0,0] op_sel_hi:[1,0,1]
    v_pk_fma_f32 v[60:61], v[108:109], v[150:151], v[60:61] op_sel:[0,0,0] op_sel_hi:[1,0,1]
    v_pk_fma_f32 v[62:63], v[110:111], v[150:151], v[62:63] op_sel:[0,0,0] op_sel_hi:[1,0,1]
    v_pk_fma_f32 v[64:65], v[112:113], v[150:151], v[64:65] op_sel:[0,0,0] op_sel_hi:[1,0,1]
    v_pk_fma_f32 v[66:67], v[114:115], v[150:151], v[66:67] op_sel:[0,0,0] op_sel_hi:[1,0,1]
    v_pk_mul_f32 v[52:53], v[52:53], v[150:151] op_sel:[0,1] op_sel_hi:[1,1]
    v_pk_mul_f32 v[54:55], v[54:55], v[150:151] op_sel:[0,1] op_sel_hi:[1,1]
    v_pk_mul_f32 v[60:61], v[60:61], v[150:151] op_sel:[0,1] op_sel_hi:[1,1]
    v_pk_mul_f32 v[62:63], v[62:63], v[150:151] op_sel:[0,1] op_sel_hi:[1,1]
    v_pk_mul_f32 v[52:53], v[52:53], v[56:57] op_sel:[0,0] op_sel_hi:[1,1]
    v_pk_mul_f32 v[54:55], v[54:55], v[58:59] op_sel:[0,0] op_sel_hi:[1,1]
    v_pk_mul_f32 v[60:61], v[60:61], v[64:65] op_sel:[0,0] op_sel_hi:[1,1]
    v_pk_mul_f32 v[62:63], v[62:63], v[66:67] op_sel:[0,0] op_sel_hi:[1,1]
    v_cvt_pk_bf16_f32 v56, v52, v53
    v_cvt_pk_bf16_f32 v57, v54, v55
    v_cvt_pk_bf16_f32 v58, v60, v61
    v_cvt_pk_bf16_f32 v59, v62, v63
    buffer_store_dwordx4 v[56:59], v159, s[12:15], s22 offen offset:0 sc1
    s_waitcnt lgkmcnt(4)
    v_pk_fma_f32 v[20:21], v[116:117], v[148:149], v[20:21] op_sel:[0,0,0] op_sel_hi:[1,0,1]
    v_pk_fma_f32 v[22:23], v[118:119], v[148:149], v[22:23] op_sel:[0,0,0] op_sel_hi:[1,0,1]
    v_pk_fma_f32 v[24:25], v[120:121], v[148:149], v[24:25] op_sel:[0,0,0] op_sel_hi:[1,0,1]
    v_pk_fma_f32 v[26:27], v[122:123], v[148:149], v[26:27] op_sel:[0,0,0] op_sel_hi:[1,0,1]
    v_pk_fma_f32 v[28:29], v[124:125], v[148:149], v[28:29] op_sel:[0,0,0] op_sel_hi:[1,0,1]
    v_pk_fma_f32 v[30:31], v[126:127], v[148:149], v[30:31] op_sel:[0,0,0] op_sel_hi:[1,0,1]
    v_pk_fma_f32 v[32:33], v[128:129], v[148:149], v[32:33] op_sel:[0,0,0] op_sel_hi:[1,0,1]
    v_pk_fma_f32 v[34:35], v[130:131], v[148:149], v[34:35] op_sel:[0,0,0] op_sel_hi:[1,0,1]
    v_pk_mul_f32 v[20:21], v[20:21], v[148:149] op_sel:[0,1] op_sel_hi:[1,1]
    v_pk_mul_f32 v[22:23], v[22:23], v[148:149] op_sel:[0,1] op_sel_hi:[1,1]
    v_pk_mul_f32 v[28:29], v[28:29], v[148:149] op_sel:[0,1] op_sel_hi:[1,1]
    v_pk_mul_f32 v[30:31], v[30:31], v[148:149] op_sel:[0,1] op_sel_hi:[1,1]
    v_pk_mul_f32 v[20:21], v[20:21], v[24:25] op_sel:[0,0] op_sel_hi:[1,1]
    v_pk_mul_f32 v[22:23], v[22:23], v[26:27] op_sel:[0,0] op_sel_hi:[1,1]
    v_pk_mul_f32 v[28:29], v[28:29], v[32:33] op_sel:[0,0] op_sel_hi:[1,1]
    v_pk_mul_f32 v[30:31], v[30:31], v[34:35] op_sel:[0,0] op_sel_hi:[1,1]
    v_cvt_pk_bf16_f32 v24, v20, v21
    v_cvt_pk_bf16_f32 v25, v22, v23
    v_cvt_pk_bf16_f32 v26, v28, v29
    v_cvt_pk_bf16_f32 v27, v30, v31
    buffer_store_dwordx4 v[24:27], v159, s[12:15], 0 offen offset:512 sc1
    v_pk_fma_f32 v[68:69], v[116:117], v[150:151], v[68:69] op_sel:[0,0,0] op_sel_hi:[1,0,1]
    v_pk_fma_f32 v[70:71], v[118:119], v[150:151], v[70:71] op_sel:[0,0,0] op_sel_hi:[1,0,1]
    v_pk_fma_f32 v[72:73], v[120:121], v[150:151], v[72:73] op_sel:[0,0,0] op_sel_hi:[1,0,1]
    v_pk_fma_f32 v[74:75], v[122:123], v[150:151], v[74:75] op_sel:[0,0,0] op_sel_hi:[1,0,1]
    v_pk_fma_f32 v[76:77], v[124:125], v[150:151], v[76:77] op_sel:[0,0,0] op_sel_hi:[1,0,1]
    v_pk_fma_f32 v[78:79], v[126:127], v[150:151], v[78:79] op_sel:[0,0,0] op_sel_hi:[1,0,1]
    v_pk_fma_f32 v[80:81], v[128:129], v[150:151], v[80:81] op_sel:[0,0,0] op_sel_hi:[1,0,1]
    v_pk_fma_f32 v[82:83], v[130:131], v[150:151], v[82:83] op_sel:[0,0,0] op_sel_hi:[1,0,1]
    v_pk_mul_f32 v[68:69], v[68:69], v[150:151] op_sel:[0,1] op_sel_hi:[1,1]
    v_pk_mul_f32 v[70:71], v[70:71], v[150:151] op_sel:[0,1] op_sel_hi:[1,1]
    v_pk_mul_f32 v[76:77], v[76:77], v[150:151] op_sel:[0,1] op_sel_hi:[1,1]
    v_pk_mul_f32 v[78:79], v[78:79], v[150:151] op_sel:[0,1] op_sel_hi:[1,1]
    v_pk_mul_f32 v[68:69], v[68:69], v[72:73] op_sel:[0,0] op_sel_hi:[1,1]
    v_pk_mul_f32 v[70:71], v[70:71], v[74:75] op_sel:[0,0] op_sel_hi:[1,1]
    v_pk_mul_f32 v[76:77], v[76:77], v[80:81] op_sel:[0,0] op_sel_hi:[1,1]
    v_pk_mul_f32 v[78:79], v[78:79], v[82:83] op_sel:[0,0] op_sel_hi:[1,1]
    v_cvt_pk_bf16_f32 v72, v68, v69
    v_cvt_pk_bf16_f32 v73, v70, v71
    v_cvt_pk_bf16_f32 v74, v76, v77
    v_cvt_pk_bf16_f32 v75, v78, v79
    buffer_store_dwordx4 v[72:75], v159, s[12:15], s22 offen offset:512 sc1
    s_waitcnt lgkmcnt(0)
    v_pk_fma_f32 v[36:37], v[132:133], v[148:149], v[36:37] op_sel:[0,0,0] op_sel_hi:[1,0,1]
    v_pk_fma_f32 v[38:39], v[134:135], v[148:149], v[38:39] op_sel:[0,0,0] op_sel_hi:[1,0,1]
    v_pk_fma_f32 v[40:41], v[136:137], v[148:149], v[40:41] op_sel:[0,0,0] op_sel_hi:[1,0,1]
    v_pk_fma_f32 v[42:43], v[138:139], v[148:149], v[42:43] op_sel:[0,0,0] op_sel_hi:[1,0,1]
    v_pk_fma_f32 v[44:45], v[140:141], v[148:149], v[44:45] op_sel:[0,0,0] op_sel_hi:[1,0,1]
    v_pk_fma_f32 v[46:47], v[142:143], v[148:149], v[46:47] op_sel:[0,0,0] op_sel_hi:[1,0,1]
    v_pk_fma_f32 v[48:49], v[144:145], v[148:149], v[48:49] op_sel:[0,0,0] op_sel_hi:[1,0,1]
    v_pk_fma_f32 v[50:51], v[146:147], v[148:149], v[50:51] op_sel:[0,0,0] op_sel_hi:[1,0,1]
    v_pk_mul_f32 v[36:37], v[36:37], v[148:149] op_sel:[0,1] op_sel_hi:[1,1]
    v_pk_mul_f32 v[38:39], v[38:39], v[148:149] op_sel:[0,1] op_sel_hi:[1,1]
    v_pk_mul_f32 v[44:45], v[44:45], v[148:149] op_sel:[0,1] op_sel_hi:[1,1]
    v_pk_mul_f32 v[46:47], v[46:47], v[148:149] op_sel:[0,1] op_sel_hi:[1,1]
    v_pk_mul_f32 v[36:37], v[36:37], v[40:41] op_sel:[0,0] op_sel_hi:[1,1]
    v_pk_mul_f32 v[38:39], v[38:39], v[42:43] op_sel:[0,0] op_sel_hi:[1,1]
    v_pk_mul_f32 v[44:45], v[44:45], v[48:49] op_sel:[0,0] op_sel_hi:[1,1]
    v_pk_mul_f32 v[46:47], v[46:47], v[50:51] op_sel:[0,0] op_sel_hi:[1,1]
    v_cvt_pk_bf16_f32 v40, v36, v37
    v_cvt_pk_bf16_f32 v41, v38, v39
    v_cvt_pk_bf16_f32 v42, v44, v45
    v_cvt_pk_bf16_f32 v43, v46, v47
    buffer_store_dwordx4 v[40:43], v159, s[12:15], 0 offen offset:1024 sc1
    v_pk_fma_f32 v[84:85], v[132:133], v[150:151], v[84:85] op_sel:[0,0,0] op_sel_hi:[1,0,1]
    v_pk_fma_f32 v[86:87], v[134:135], v[150:151], v[86:87] op_sel:[0,0,0] op_sel_hi:[1,0,1]
    v_pk_fma_f32 v[88:89], v[136:137], v[150:151], v[88:89] op_sel:[0,0,0] op_sel_hi:[1,0,1]
    v_pk_fma_f32 v[90:91], v[138:139], v[150:151], v[90:91] op_sel:[0,0,0] op_sel_hi:[1,0,1]
    v_pk_fma_f32 v[92:93], v[140:141], v[150:151], v[92:93] op_sel:[0,0,0] op_sel_hi:[1,0,1]
    v_pk_fma_f32 v[94:95], v[142:143], v[150:151], v[94:95] op_sel:[0,0,0] op_sel_hi:[1,0,1]
    v_pk_fma_f32 v[96:97], v[144:145], v[150:151], v[96:97] op_sel:[0,0,0] op_sel_hi:[1,0,1]
    v_pk_fma_f32 v[98:99], v[146:147], v[150:151], v[98:99] op_sel:[0,0,0] op_sel_hi:[1,0,1]
    v_pk_mul_f32 v[84:85], v[84:85], v[150:151] op_sel:[0,1] op_sel_hi:[1,1]
    v_pk_mul_f32 v[86:87], v[86:87], v[150:151] op_sel:[0,1] op_sel_hi:[1,1]
    v_pk_mul_f32 v[92:93], v[92:93], v[150:151] op_sel:[0,1] op_sel_hi:[1,1]
    v_pk_mul_f32 v[94:95], v[94:95], v[150:151] op_sel:[0,1] op_sel_hi:[1,1]
    v_pk_mul_f32 v[84:85], v[84:85], v[88:89] op_sel:[0,0] op_sel_hi:[1,1]
    v_pk_mul_f32 v[86:87], v[86:87], v[90:91] op_sel:[0,0] op_sel_hi:[1,1]
    v_pk_mul_f32 v[92:93], v[92:93], v[96:97] op_sel:[0,0] op_sel_hi:[1,1]
    v_pk_mul_f32 v[94:95], v[94:95], v[98:99] op_sel:[0,0] op_sel_hi:[1,1]
    v_cvt_pk_bf16_f32 v88, v84, v85
    v_cvt_pk_bf16_f32 v89, v86, v87
    v_cvt_pk_bf16_f32 v90, v92, v93
    v_cvt_pk_bf16_f32 v91, v94, v95
    buffer_store_dwordx4 v[88:91], v159, s[12:15], s22 offen offset:1024 sc1
    s_barrier
    s_load_dwordx2 s[32:33], s[0:1], 56
    s_lshl_b32 s36, s25, 2
    s_add_u32 s36, s36, s20
    s_and_b32 s22, s20, 1
    s_lshl_b32 s21, s22, 10
    s_add_u32 s21, s21, 19955712
    s_mul_i32 s34, s36, 49152
    s_add_u32 s34, s34, s21
    s_xor_b32 s35, s36, 1
    s_mul_i32 s35, s35, 49152
    s_add_u32 s35, s35, s21
    s_mul_i32 s3, s22, 5120
    v_and_b32 v64, 15, v1
    v_lshrrev_b32 v65, 4, v1
    s_lshl_b32 s21, s36, 4
    v_add_u32 v66, s21, v64
    v_mul_u32_u24 v67, 1280, v66
    s_mul_i32 s21, s26, 160
    v_add_u32 v67, s21, v67
    v_lshl_add_u32 v158, v65, 4, v67
    v_lshl_add_u32 v160, v65, 3, v67
    s_lshr_b32 s21, s36, 1
    s_mul_i32 s21, s21, 40960
    s_and_b32 s22, s36, 1
    s_lshl_b32 s22, s22, 8
    s_add_u32 s21, s21, s22
    s_mul_i32 s22, s26, 5120
    s_add_u32 s21, s21, s22
    s_add_u32 s21, s21, 17203200
    v_lshl_add_u32 v64, v64, 4, s21
    v_lshl_add_u32 v159, v65, 9, v64
    v_lshrrev_b32 v68, 1, v65
    v_lshl_add_u32 v64, v68, 9, v64
    v_and_b32 v65, 1, v65
    v_lshl_add_u32 v64, v65, 3, v64
    v_add_u32 v161, 4096, v64
    s_waitcnt lgkmcnt(0)
    s_mov_b32 s40, s32
    s_mov_b32 s41, s33
    s_mov_b32 s42, 0x280000
    s_mov_b32 s43, 0x20000
    buffer_load_dwordx4 v[148:151], v159, s[12:15], 0 offen sc1
    buffer_load_dwordx4 v[152:155], v159, s[12:15], 0 offen offset:2048 sc1
    buffer_load_dwordx2 v[156:157], v161, s[12:15], 0 offen sc1
    v_add_u32 v162, s3, v2
    v_add_u32 v164, 122880, v162
    v_add_u32 v163, 61440, v162
    v_add_u32 v162, 0, v162
    s_lshr_b32 s23, s27, 1
    s_and_b32 s21, s27, 1
    s_lshl4_add_u32 s23, s21, s23
    v_and_b32 v75, 1, v1
    v_lshrrev_b32 v74, 1, v1
    v_lshlrev_b32 v75, 10, v75
    v_lshl_add_u32 v75, v74, 12, v75
    s_lshl_b32 s23, s23, 7
    s_add_u32 s23, s23, 26345472
    v_mov_b32 v72, 163592
    v_mov_b32 v73, 1
    s_mov_b64 exec, 1
    s_waitcnt vmcnt(3)
    ds_add_rtn_u32 v74, v72, v73
    s_waitcnt lgkmcnt(0)
    v_readfirstlane_b32 s21, v74
    s_cmp_eq_u32 s21, 0
    s_cbranch_scc1 L_kf_fus_poll_18_0
    s_cmp_eq_u32 s21, 3
    s_cbranch_scc0 L_kf_fus_go_17
    s_mov_b32 exec_lo, 0xffff
    buffer_atomic_add v73, v75, s[12:15], s23 offen offset:8 sc1
    s_branch L_kf_fus_go_17
L_kf_fus_poll_18_0:
    s_mov_b32 s21, 16384
L_kf_fus_poll_18:
    buffer_load_dword v74, off, s[12:15], s24 offset:8 sc1
    s_sub_u32 s21, s21, 1
    s_waitcnt vmcnt(0)
    v_cmp_ne_u32 vcc, 16, v74
    s_cmp_eq_u32 s21, 0
    s_cbranch_scc1 L_kf_fus_go_17
    s_cbranch_vccnz L_kf_fus_poll_18
L_kf_fus_go_17:
    s_mov_b64 exec, -1
    s_barrier
    buffer_load_dwordx4 v[88:91], v2, s[12:15], s35 offen offset:0 sc1
    buffer_load_dwordx4 v[84:87], v2, s[12:15], s34 offen offset:0 sc1
    buffer_load_dwordx4 v[96:99], v2, s[12:15], s35 offen offset:2048 sc1
    s_add_u32 s35, s35, 4096
    buffer_load_dwordx4 v[92:95], v2, s[12:15], s34 offen offset:2048 sc1
    s_add_u32 s34, s34, 4096
    buffer_load_dwordx4 v[104:107], v2, s[12:15], s35 offen offset:0 sc1
    buffer_load_dwordx4 v[100:103], v2, s[12:15], s34 offen offset:0 sc1
    buffer_load_dwordx4 v[112:115], v2, s[12:15], s35 offen offset:2048 sc1
    s_add_u32 s35, s35, 4096
    buffer_load_dwordx4 v[108:111], v2, s[12:15], s34 offen offset:2048 sc1
    s_add_u32 s34, s34, 4096
    buffer_load_dwordx4 v[120:123], v2, s[12:15], s35 offen offset:0 sc1
    buffer_load_dwordx4 v[116:119], v2, s[12:15], s34 offen offset:0 sc1
    buffer_load_dwordx4 v[128:131], v2, s[12:15], s35 offen offset:2048 sc1
    s_add_u32 s35, s35, 4096
    buffer_load_dwordx4 v[124:127], v2, s[12:15], s34 offen offset:2048 sc1
    s_add_u32 s34, s34, 4096
    buffer_load_dwordx4 v[136:139], v2, s[12:15], s35 offen offset:0 sc1
    buffer_load_dwordx4 v[132:135], v2, s[12:15], s34 offen offset:0 sc1
    buffer_load_dwordx4 v[144:147], v2, s[12:15], s35 offen offset:2048 sc1
    s_add_u32 s35, s35, 4096
    buffer_load_dwordx4 v[140:143], v2, s[12:15], s34 offen offset:2048 sc1
    s_add_u32 s34, s34, 4096
    s_barrier
    ds_read_b128 v[44:47], v162 offset:0
    ds_read_b128 v[48:51], v162 offset:1024
    ds_read_b128 v[52:55], v162 offset:2048
    ds_read_b128 v[56:59], v162 offset:3072
    ds_read_b128 v[60:63], v162 offset:4096
    s_waitcnt vmcnt(15) lgkmcnt(0)
    v_mfma_f32_16x16x32_bf16 v[24:27], v[44:47], v[88:91], 0
    ds_read_b128 v[64:67], v162 offset:10240
    v_mfma_f32_16x16x32_bf16 v[28:31], v[48:51], v[88:91], 0
    ds_read_b128 v[68:71], v162 offset:11264
    v_mfma_f32_16x16x32_bf16 v[32:35], v[52:55], v[88:91], 0
    ds_read_b128 v[72:75], v162 offset:12288
    v_mfma_f32_16x16x32_bf16 v[36:39], v[56:59], v[88:91], 0
    ds_read_b128 v[76:79], v162 offset:13312
    v_mfma_f32_16x16x32_bf16 v[40:43], v[60:63], v[88:91], 0
    ds_read_b128 v[80:83], v162 offset:14336
    s_waitcnt vmcnt(14)
    v_mfma_f32_16x16x32_bf16 v[4:7], v[44:47], v[84:87], 0
    v_mfma_f32_16x16x32_bf16 v[8:11], v[48:51], v[84:87], 0
    v_mfma_f32_16x16x32_bf16 v[12:15], v[52:55], v[84:87], 0
    v_mfma_f32_16x16x32_bf16 v[16:19], v[56:59], v[84:87], 0
    v_mfma_f32_16x16x32_bf16 v[20:23], v[60:63], v[84:87], 0
    s_waitcnt vmcnt(13) lgkmcnt(0)
    v_mfma_f32_16x16x32_bf16 v[24:27], v[64:67], v[96:99], v[24:27]
    s_barrier
    ds_read_b128 v[44:47], v162 offset:20480
    v_mfma_f32_16x16x32_bf16 v[28:31], v[68:71], v[96:99], v[28:31]
    ds_read_b128 v[48:51], v162 offset:21504
    v_mfma_f32_16x16x32_bf16 v[32:35], v[72:75], v[96:99], v[32:35]
    ds_read_b128 v[52:55], v162 offset:22528
    v_mfma_f32_16x16x32_bf16 v[36:39], v[76:79], v[96:99], v[36:39]
    ds_read_b128 v[56:59], v162 offset:23552
    v_mfma_f32_16x16x32_bf16 v[40:43], v[80:83], v[96:99], v[40:43]
    ds_read_b128 v[60:63], v162 offset:24576
    s_waitcnt vmcnt(12)
    v_mfma_f32_16x16x32_bf16 v[4:7], v[64:67], v[92:95], v[4:7]
    buffer_load_dwordx4 v[88:91], v2, s[12:15], s35 offen offset:0 sc1
    v_mfma_f32_16x16x32_bf16 v[8:11], v[68:71], v[92:95], v[8:11]
    v_mfma_f32_16x16x32_bf16 v[12:15], v[72:75], v[92:95], v[12:15]
    buffer_load_dwordx4 v[84:87], v2, s[12:15], s34 offen offset:0 sc1
    v_mfma_f32_16x16x32_bf16 v[16:19], v[76:79], v[92:95], v[16:19]
    v_mfma_f32_16x16x32_bf16 v[20:23], v[80:83], v[92:95], v[20:23]
    s_waitcnt vmcnt(13) lgkmcnt(0)
    v_mfma_f32_16x16x32_bf16 v[24:27], v[44:47], v[104:107], v[24:27]
    ds_read_b128 v[64:67], v162 offset:30720
    v_mfma_f32_16x16x32_bf16 v[28:31], v[48:51], v[104:107], v[28:31]
    ds_read_b128 v[68:71], v162 offset:31744
    v_mfma_f32_16x16x32_bf16 v[32:35], v[52:55], v[104:107], v[32:35]
    ds_read_b128 v[72:75], v162 offset:32768
    v_mfma_f32_16x16x32_bf16 v[36:39], v[56:59], v[104:107], v[36:39]
    ds_read_b128 v[76:79], v162 offset:33792
    v_mfma_f32_16x16x32_bf16 v[40:43], v[60:63], v[104:107], v[40:43]
    ds_read_b128 v[80:83], v162 offset:34816
    s_waitcnt vmcnt(12)
    v_mfma_f32_16x16x32_bf16 v[4:7], v[44:47], v[100:103], v[4:7]
    buffer_load_dwordx4 v[96:99], v2, s[12:15], s35 offen offset:2048 sc1
    s_add_u32 s35, s35, 4096
    v_mfma_f32_16x16x32_bf16 v[8:11], v[48:51], v[100:103], v[8:11]
    v_mfma_f32_16x16x32_bf16 v[12:15], v[52:55], v[100:103], v[12:15]
    buffer_load_dwordx4 v[92:95], v2, s[12:15], s34 offen offset:2048 sc1
    s_add_u32 s34, s34, 4096
    v_mfma_f32_16x16x32_bf16 v[16:19], v[56:59], v[100:103], v[16:19]
    v_mfma_f32_16x16x32_bf16 v[20:23], v[60:63], v[100:103], v[20:23]
    s_waitcnt vmcnt(13) lgkmcnt(0)
    v_mfma_f32_16x16x32_bf16 v[24:27], v[64:67], v[112:115], v[24:27]
    s_barrier
    ds_read_b128 v[44:47], v162 offset:40960
    v_mfma_f32_16x16x32_bf16 v[28:31], v[68:71], v[112:115], v[28:31]
    ds_read_b128 v[48:51], v162 offset:41984
    v_mfma_f32_16x16x32_bf16 v[32:35], v[72:75], v[112:115], v[32:35]
    ds_read_b128 v[52:55], v162 offset:43008
    v_mfma_f32_16x16x32_bf16 v[36:39], v[76:79], v[112:115], v[36:39]
    ds_read_b128 v[56:59], v162 offset:44032
    v_mfma_f32_16x16x32_bf16 v[40:43], v[80:83], v[112:115], v[40:43]
    ds_read_b128 v[60:63], v162 offset:45056
    s_waitcnt vmcnt(12)
    v_mfma_f32_16x16x32_bf16 v[4:7], v[64:67], v[108:111], v[4:7]
    buffer_load_dwordx4 v[104:107], v2, s[12:15], s35 offen offset:0 sc1
    v_mfma_f32_16x16x32_bf16 v[8:11], v[68:71], v[108:111], v[8:11]
    v_mfma_f32_16x16x32_bf16 v[12:15], v[72:75], v[108:111], v[12:15]
    buffer_load_dwordx4 v[100:103], v2, s[12:15], s34 offen offset:0 sc1
    v_mfma_f32_16x16x32_bf16 v[16:19], v[76:79], v[108:111], v[16:19]
    v_mfma_f32_16x16x32_bf16 v[20:23], v[80:83], v[108:111], v[20:23]
    s_waitcnt vmcnt(13) lgkmcnt(0)
    v_mfma_f32_16x16x32_bf16 v[24:27], v[44:47], v[120:123], v[24:27]
    ds_read_b128 v[64:67], v162 offset:51200
    v_mfma_f32_16x16x32_bf16 v[28:31], v[48:51], v[120:123], v[28:31]
    ds_read_b128 v[68:71], v162 offset:52224
    v_mfma_f32_16x16x32_bf16 v[32:35], v[52:55], v[120:123], v[32:35]
    ds_read_b128 v[72:75], v162 offset:53248
    v_mfma_f32_16x16x32_bf16 v[36:39], v[56:59], v[120:123], v[36:39]
    ds_read_b128 v[76:79], v162 offset:54272
    v_mfma_f32_16x16x32_bf16 v[40:43], v[60:63], v[120:123], v[40:43]
    ds_read_b128 v[80:83], v162 offset:55296
    s_waitcnt vmcnt(12)
    v_mfma_f32_16x16x32_bf16 v[4:7], v[44:47], v[116:119], v[4:7]
    buffer_load_dwordx4 v[112:115], v2, s[12:15], s35 offen offset:2048 sc1
    s_add_u32 s35, s35, 4096
    v_mfma_f32_16x16x32_bf16 v[8:11], v[48:51], v[116:119], v[8:11]
    v_mfma_f32_16x16x32_bf16 v[12:15], v[52:55], v[116:119], v[12:15]
    buffer_load_dwordx4 v[108:111], v2, s[12:15], s34 offen offset:2048 sc1
    s_add_u32 s34, s34, 4096
    v_mfma_f32_16x16x32_bf16 v[16:19], v[56:59], v[116:119], v[16:19]
    v_mfma_f32_16x16x32_bf16 v[20:23], v[60:63], v[116:119], v[20:23]
    s_waitcnt vmcnt(13) lgkmcnt(0)
    v_mfma_f32_16x16x32_bf16 v[24:27], v[64:67], v[128:131], v[24:27]
    s_barrier
    ds_read_b128 v[44:47], v163 offset:0
    v_mfma_f32_16x16x32_bf16 v[28:31], v[68:71], v[128:131], v[28:31]
    ds_read_b128 v[48:51], v163 offset:1024
    v_mfma_f32_16x16x32_bf16 v[32:35], v[72:75], v[128:131], v[32:35]
    ds_read_b128 v[52:55], v163 offset:2048
    v_mfma_f32_16x16x32_bf16 v[36:39], v[76:79], v[128:131], v[36:39]
    ds_read_b128 v[56:59], v163 offset:3072
    v_mfma_f32_16x16x32_bf16 v[40:43], v[80:83], v[128:131], v[40:43]
    ds_read_b128 v[60:63], v163 offset:4096
    s_waitcnt vmcnt(12)
    v_mfma_f32_16x16x32_bf16 v[4:7], v[64:67], v[124:127], v[4:7]
    buffer_load_dwordx4 v[120:123], v2, s[12:15], s35 offen offset:0 sc1
    v_mfma_f32_16x16x32_bf16 v[8:11], v[68:71], v[124:127], v[8:11]
    v_mfma_f32_16x16x32_bf16 v[12:15], v[72:75], v[124:127], v[12:15]
    buffer_load_dwordx4 v[116:119], v2, s[12:15], s34 offen offset:0 sc1
    v_mfma_f32_16x16x32_bf16 v[16:19], v[76:79], v[124:127], v[16:19]
    v_mfma_f32_16x16x32_bf16 v[20:23], v[80:83], v[124:127], v[20:23]
    s_waitcnt vmcnt(13) lgkmcnt(0)
    v_mfma_f32_16x16x32_bf16 v[24:27], v[44:47], v[136:139], v[24:27]
    ds_read_b128 v[64:67], v163 offset:10240
    v_mfma_f32_16x16x32_bf16 v[28:31], v[48:51], v[136:139], v[28:31]
    ds_read_b128 v[68:71], v163 offset:11264
    v_mfma_f32_16x16x32_bf16 v[32:35], v[52:55], v[136:139], v[32:35]
    ds_read_b128 v[72:75], v163 offset:12288
    v_mfma_f32_16x16x32_bf16 v[36:39], v[56:59], v[136:139], v[36:39]
    ds_read_b128 v[76:79], v163 offset:13312
    v_mfma_f32_16x16x32_bf16 v[40:43], v[60:63], v[136:139], v[40:43]
    ds_read_b128 v[80:83], v163 offset:14336
    s_waitcnt vmcnt(12)
    v_mfma_f32_16x16x32_bf16 v[4:7], v[44:47], v[132:135], v[4:7]
    buffer_load_dwordx4 v[128:131], v2, s[12:15], s35 offen offset:2048 sc1
    s_add_u32 s35, s35, 4096
    v_mfma_f32_16x16x32_bf16 v[8:11], v[48:51], v[132:135], v[8:11]
    v_mfma_f32_16x16x32_bf16 v[12:15], v[52:55], v[132:135], v[12:15]
    buffer_load_dwordx4 v[124:127], v2, s[12:15], s34 offen offset:2048 sc1
    s_add_u32 s34, s34, 4096
    v_mfma_f32_16x16x32_bf16 v[16:19], v[56:59], v[132:135], v[16:19]
    v_mfma_f32_16x16x32_bf16 v[20:23], v[60:63], v[132:135], v[20:23]
    s_waitcnt vmcnt(13) lgkmcnt(0)
    v_mfma_f32_16x16x32_bf16 v[24:27], v[64:67], v[144:147], v[24:27]
    s_barrier
    ds_read_b128 v[44:47], v163 offset:20480
    v_mfma_f32_16x16x32_bf16 v[28:31], v[68:71], v[144:147], v[28:31]
    ds_read_b128 v[48:51], v163 offset:21504
    v_mfma_f32_16x16x32_bf16 v[32:35], v[72:75], v[144:147], v[32:35]
    ds_read_b128 v[52:55], v163 offset:22528
    v_mfma_f32_16x16x32_bf16 v[36:39], v[76:79], v[144:147], v[36:39]
    ds_read_b128 v[56:59], v163 offset:23552
    v_mfma_f32_16x16x32_bf16 v[40:43], v[80:83], v[144:147], v[40:43]
    ds_read_b128 v[60:63], v163 offset:24576
    s_waitcnt vmcnt(12)
    v_mfma_f32_16x16x32_bf16 v[4:7], v[64:67], v[140:143], v[4:7]
    buffer_load_dwordx4 v[136:139], v2, s[12:15], s35 offen offset:0 sc1
    v_mfma_f32_16x16x32_bf16 v[8:11], v[68:71], v[140:143], v[8:11]
    v_mfma_f32_16x16x32_bf16 v[12:15], v[72:75], v[140:143], v[12:15]
    buffer_load_dwordx4 v[132:135], v2, s[12:15], s34 offen offset:0 sc1
    v_mfma_f32_16x16x32_bf16 v[16:19], v[76:79], v[140:143], v[16:19]
    v_mfma_f32_16x16x32_bf16 v[20:23], v[80:83], v[140:143], v[20:23]
    s_waitcnt vmcnt(13) lgkmcnt(0)
    v_mfma_f32_16x16x32_bf16 v[24:27], v[44:47], v[88:91], v[24:27]
    ds_read_b128 v[64:67], v163 offset:30720
    v_mfma_f32_16x16x32_bf16 v[28:31], v[48:51], v[88:91], v[28:31]
    ds_read_b128 v[68:71], v163 offset:31744
    v_mfma_f32_16x16x32_bf16 v[32:35], v[52:55], v[88:91], v[32:35]
    ds_read_b128 v[72:75], v163 offset:32768
    v_mfma_f32_16x16x32_bf16 v[36:39], v[56:59], v[88:91], v[36:39]
    ds_read_b128 v[76:79], v163 offset:33792
    v_mfma_f32_16x16x32_bf16 v[40:43], v[60:63], v[88:91], v[40:43]
    ds_read_b128 v[80:83], v163 offset:34816
    s_waitcnt vmcnt(12)
    v_mfma_f32_16x16x32_bf16 v[4:7], v[44:47], v[84:87], v[4:7]
    buffer_load_dwordx4 v[144:147], v2, s[12:15], s35 offen offset:2048 sc1
    s_add_u32 s35, s35, 4096
    v_mfma_f32_16x16x32_bf16 v[8:11], v[48:51], v[84:87], v[8:11]
    v_mfma_f32_16x16x32_bf16 v[12:15], v[52:55], v[84:87], v[12:15]
    buffer_load_dwordx4 v[140:143], v2, s[12:15], s34 offen offset:2048 sc1
    s_add_u32 s34, s34, 4096
    v_mfma_f32_16x16x32_bf16 v[16:19], v[56:59], v[84:87], v[16:19]
    v_mfma_f32_16x16x32_bf16 v[20:23], v[60:63], v[84:87], v[20:23]
    s_waitcnt vmcnt(13) lgkmcnt(0)
    v_mfma_f32_16x16x32_bf16 v[24:27], v[64:67], v[96:99], v[24:27]
    s_barrier
    ds_read_b128 v[44:47], v163 offset:40960
    v_mfma_f32_16x16x32_bf16 v[28:31], v[68:71], v[96:99], v[28:31]
    ds_read_b128 v[48:51], v163 offset:41984
    v_mfma_f32_16x16x32_bf16 v[32:35], v[72:75], v[96:99], v[32:35]
    ds_read_b128 v[52:55], v163 offset:43008
    v_mfma_f32_16x16x32_bf16 v[36:39], v[76:79], v[96:99], v[36:39]
    ds_read_b128 v[56:59], v163 offset:44032
    v_mfma_f32_16x16x32_bf16 v[40:43], v[80:83], v[96:99], v[40:43]
    ds_read_b128 v[60:63], v163 offset:45056
    s_waitcnt vmcnt(12)
    v_mfma_f32_16x16x32_bf16 v[4:7], v[64:67], v[92:95], v[4:7]
    buffer_load_dwordx4 v[88:91], v2, s[12:15], s35 offen offset:0 sc1
    v_mfma_f32_16x16x32_bf16 v[8:11], v[68:71], v[92:95], v[8:11]
    v_mfma_f32_16x16x32_bf16 v[12:15], v[72:75], v[92:95], v[12:15]
    buffer_load_dwordx4 v[84:87], v2, s[12:15], s34 offen offset:0 sc1
    v_mfma_f32_16x16x32_bf16 v[16:19], v[76:79], v[92:95], v[16:19]
    v_mfma_f32_16x16x32_bf16 v[20:23], v[80:83], v[92:95], v[20:23]
    s_waitcnt vmcnt(13) lgkmcnt(0)
    v_mfma_f32_16x16x32_bf16 v[24:27], v[44:47], v[104:107], v[24:27]
    ds_read_b128 v[64:67], v163 offset:51200
    v_mfma_f32_16x16x32_bf16 v[28:31], v[48:51], v[104:107], v[28:31]
    ds_read_b128 v[68:71], v163 offset:52224
    v_mfma_f32_16x16x32_bf16 v[32:35], v[52:55], v[104:107], v[32:35]
    ds_read_b128 v[72:75], v163 offset:53248
    v_mfma_f32_16x16x32_bf16 v[36:39], v[56:59], v[104:107], v[36:39]
    ds_read_b128 v[76:79], v163 offset:54272
    v_mfma_f32_16x16x32_bf16 v[40:43], v[60:63], v[104:107], v[40:43]
    ds_read_b128 v[80:83], v163 offset:55296
    s_waitcnt vmcnt(12)
    v_mfma_f32_16x16x32_bf16 v[4:7], v[44:47], v[100:103], v[4:7]
    buffer_load_dwordx4 v[96:99], v2, s[12:15], s35 offen offset:2048 sc1
    s_add_u32 s35, s35, 4096
    v_mfma_f32_16x16x32_bf16 v[8:11], v[48:51], v[100:103], v[8:11]
    v_mfma_f32_16x16x32_bf16 v[12:15], v[52:55], v[100:103], v[12:15]
    buffer_load_dwordx4 v[92:95], v2, s[12:15], s34 offen offset:2048 sc1
    s_add_u32 s34, s34, 4096
    v_mfma_f32_16x16x32_bf16 v[16:19], v[56:59], v[100:103], v[16:19]
    v_mfma_f32_16x16x32_bf16 v[20:23], v[60:63], v[100:103], v[20:23]
    s_waitcnt vmcnt(13) lgkmcnt(0)
    v_mfma_f32_16x16x32_bf16 v[24:27], v[64:67], v[112:115], v[24:27]
    s_barrier
    ds_read_b128 v[44:47], v164 offset:0
    v_mfma_f32_16x16x32_bf16 v[28:31], v[68:71], v[112:115], v[28:31]
    ds_read_b128 v[48:51], v164 offset:1024
    v_mfma_f32_16x16x32_bf16 v[32:35], v[72:75], v[112:115], v[32:35]
    ds_read_b128 v[52:55], v164 offset:2048
    v_mfma_f32_16x16x32_bf16 v[36:39], v[76:79], v[112:115], v[36:39]
    ds_read_b128 v[56:59], v164 offset:3072
    v_mfma_f32_16x16x32_bf16 v[40:43], v[80:83], v[112:115], v[40:43]
    ds_read_b128 v[60:63], v164 offset:4096
    s_waitcnt vmcnt(12)
    v_mfma_f32_16x16x32_bf16 v[4:7], v[64:67], v[108:111], v[4:7]
    buffer_load_dwordx4 v[104:107], v2, s[12:15], s35 offen offset:0 sc1
    v_mfma_f32_16x16x32_bf16 v[8:11], v[68:71], v[108:111], v[8:11]
    v_mfma_f32_16x16x32_bf16 v[12:15], v[72:75], v[108:111], v[12:15]
    buffer_load_dwordx4 v[100:103], v2, s[12:15], s34 offen offset:0 sc1
    v_mfma_f32_16x16x32_bf16 v[16:19], v[76:79], v[108:111], v[16:19]
    v_mfma_f32_16x16x32_bf16 v[20:23], v[80:83], v[108:111], v[20:23]
    s_waitcnt vmcnt(13) lgkmcnt(0)
    v_mfma_f32_16x16x32_bf16 v[24:27], v[44:47], v[120:123], v[24:27]
    ds_read_b128 v[64:67], v164 offset:10240
    v_mfma_f32_16x16x32_bf16 v[28:31], v[48:51], v[120:123], v[28:31]
    ds_read_b128 v[68:71], v164 offset:11264
    v_mfma_f32_16x16x32_bf16 v[32:35], v[52:55], v[120:123], v[32:35]
    ds_read_b128 v[72:75], v164 offset:12288
    v_mfma_f32_16x16x32_bf16 v[36:39], v[56:59], v[120:123], v[36:39]
    ds_read_b128 v[76:79], v164 offset:13312
    v_mfma_f32_16x16x32_bf16 v[40:43], v[60:63], v[120:123], v[40:43]
    ds_read_b128 v[80:83], v164 offset:14336
    s_waitcnt vmcnt(12)
    v_mfma_f32_16x16x32_bf16 v[4:7], v[44:47], v[116:119], v[4:7]
    buffer_load_dwordx4 v[112:115], v2, s[12:15], s35 offen offset:2048 sc1
    s_add_u32 s35, s35, 4096
    v_mfma_f32_16x16x32_bf16 v[8:11], v[48:51], v[116:119], v[8:11]
    v_mfma_f32_16x16x32_bf16 v[12:15], v[52:55], v[116:119], v[12:15]
    buffer_load_dwordx4 v[108:111], v2, s[12:15], s34 offen offset:2048 sc1
    s_add_u32 s34, s34, 4096
    v_mfma_f32_16x16x32_bf16 v[16:19], v[56:59], v[116:119], v[16:19]
    v_mfma_f32_16x16x32_bf16 v[20:23], v[60:63], v[116:119], v[20:23]
    s_waitcnt vmcnt(13) lgkmcnt(0)
    v_mfma_f32_16x16x32_bf16 v[24:27], v[64:67], v[128:131], v[24:27]
    s_barrier
    ds_read_b128 v[44:47], v164 offset:20480
    v_mfma_f32_16x16x32_bf16 v[28:31], v[68:71], v[128:131], v[28:31]
    ds_read_b128 v[48:51], v164 offset:21504
    v_mfma_f32_16x16x32_bf16 v[32:35], v[72:75], v[128:131], v[32:35]
    ds_read_b128 v[52:55], v164 offset:22528
    v_mfma_f32_16x16x32_bf16 v[36:39], v[76:79], v[128:131], v[36:39]
    ds_read_b128 v[56:59], v164 offset:23552
    v_mfma_f32_16x16x32_bf16 v[40:43], v[80:83], v[128:131], v[40:43]
    ds_read_b128 v[60:63], v164 offset:24576
    s_waitcnt vmcnt(12)
    v_mfma_f32_16x16x32_bf16 v[4:7], v[64:67], v[124:127], v[4:7]
    buffer_load_dwordx4 v[120:123], v2, s[12:15], s35 offen offset:0 sc1
    v_mfma_f32_16x16x32_bf16 v[8:11], v[68:71], v[124:127], v[8:11]
    v_mfma_f32_16x16x32_bf16 v[12:15], v[72:75], v[124:127], v[12:15]
    buffer_load_dwordx4 v[116:119], v2, s[12:15], s34 offen offset:0 sc1
    v_mfma_f32_16x16x32_bf16 v[16:19], v[76:79], v[124:127], v[16:19]
    v_mfma_f32_16x16x32_bf16 v[20:23], v[80:83], v[124:127], v[20:23]
    s_waitcnt vmcnt(13) lgkmcnt(0)
    v_mfma_f32_16x16x32_bf16 v[24:27], v[44:47], v[136:139], v[24:27]
    ds_read_b128 v[64:67], v164 offset:30720
    v_mfma_f32_16x16x32_bf16 v[28:31], v[48:51], v[136:139], v[28:31]
    ds_read_b128 v[68:71], v164 offset:31744
    v_mfma_f32_16x16x32_bf16 v[32:35], v[52:55], v[136:139], v[32:35]
    ds_read_b128 v[72:75], v164 offset:32768
    v_mfma_f32_16x16x32_bf16 v[36:39], v[56:59], v[136:139], v[36:39]
    ds_read_b128 v[76:79], v164 offset:33792
    v_mfma_f32_16x16x32_bf16 v[40:43], v[60:63], v[136:139], v[40:43]
    ds_read_b128 v[80:83], v164 offset:34816
    s_waitcnt vmcnt(12)
    v_mfma_f32_16x16x32_bf16 v[4:7], v[44:47], v[132:135], v[4:7]
    buffer_load_dwordx4 v[128:131], v2, s[12:15], s35 offen offset:2048 sc1
    s_add_u32 s35, s35, 4096
    v_mfma_f32_16x16x32_bf16 v[8:11], v[48:51], v[132:135], v[8:11]
    v_mfma_f32_16x16x32_bf16 v[12:15], v[52:55], v[132:135], v[12:15]
    buffer_load_dwordx4 v[124:127], v2, s[12:15], s34 offen offset:2048 sc1
    s_add_u32 s34, s34, 4096
    v_mfma_f32_16x16x32_bf16 v[16:19], v[56:59], v[132:135], v[16:19]
    v_mfma_f32_16x16x32_bf16 v[20:23], v[60:63], v[132:135], v[20:23]
    s_waitcnt vmcnt(13) lgkmcnt(0)
    v_mfma_f32_16x16x32_bf16 v[24:27], v[64:67], v[144:147], v[24:27]
    s_barrier
    ds_read_b128 v[44:47], v162 offset:0
    v_mfma_f32_16x16x32_bf16 v[28:31], v[68:71], v[144:147], v[28:31]
    ds_read_b128 v[48:51], v162 offset:1024
    v_mfma_f32_16x16x32_bf16 v[32:35], v[72:75], v[144:147], v[32:35]
    ds_read_b128 v[52:55], v162 offset:2048
    v_mfma_f32_16x16x32_bf16 v[36:39], v[76:79], v[144:147], v[36:39]
    ds_read_b128 v[56:59], v162 offset:3072
    v_mfma_f32_16x16x32_bf16 v[40:43], v[80:83], v[144:147], v[40:43]
    ds_read_b128 v[60:63], v162 offset:4096
    s_waitcnt vmcnt(12)
    v_mfma_f32_16x16x32_bf16 v[4:7], v[64:67], v[140:143], v[4:7]
    buffer_load_dwordx4 v[136:139], v2, s[12:15], s35 offen offset:0 sc1
    v_mfma_f32_16x16x32_bf16 v[8:11], v[68:71], v[140:143], v[8:11]
    v_mfma_f32_16x16x32_bf16 v[12:15], v[72:75], v[140:143], v[12:15]
    buffer_load_dwordx4 v[132:135], v2, s[12:15], s34 offen offset:0 sc1
    v_mfma_f32_16x16x32_bf16 v[16:19], v[76:79], v[140:143], v[16:19]
    v_mfma_f32_16x16x32_bf16 v[20:23], v[80:83], v[140:143], v[20:23]
    s_waitcnt vmcnt(13) lgkmcnt(0)
    v_mfma_f32_16x16x32_bf16 v[24:27], v[44:47], v[88:91], v[24:27]
    ds_read_b128 v[64:67], v162 offset:10240
    v_mfma_f32_16x16x32_bf16 v[28:31], v[48:51], v[88:91], v[28:31]
    ds_read_b128 v[68:71], v162 offset:11264
    v_mfma_f32_16x16x32_bf16 v[32:35], v[52:55], v[88:91], v[32:35]
    ds_read_b128 v[72:75], v162 offset:12288
    v_mfma_f32_16x16x32_bf16 v[36:39], v[56:59], v[88:91], v[36:39]
    ds_read_b128 v[76:79], v162 offset:13312
    v_mfma_f32_16x16x32_bf16 v[40:43], v[60:63], v[88:91], v[40:43]
    ds_read_b128 v[80:83], v162 offset:14336
    s_waitcnt vmcnt(12)
    v_mfma_f32_16x16x32_bf16 v[4:7], v[44:47], v[84:87], v[4:7]
    buffer_load_dwordx4 v[144:147], v2, s[12:15], s35 offen offset:2048 sc1
    v_mfma_f32_16x16x32_bf16 v[8:11], v[48:51], v[84:87], v[8:11]
    v_mfma_f32_16x16x32_bf16 v[12:15], v[52:55], v[84:87], v[12:15]
    buffer_load_dwordx4 v[140:143], v2, s[12:15], s34 offen offset:2048 sc1
    v_mfma_f32_16x16x32_bf16 v[16:19], v[56:59], v[84:87], v[16:19]
    v_mfma_f32_16x16x32_bf16 v[20:23], v[60:63], v[84:87], v[20:23]
    s_waitcnt vmcnt(13) lgkmcnt(0)
    v_mfma_f32_16x16x32_bf16 v[24:27], v[64:67], v[96:99], v[24:27]
    s_barrier
    ds_read_b128 v[44:47], v162 offset:20480
    v_mfma_f32_16x16x32_bf16 v[28:31], v[68:71], v[96:99], v[28:31]
    ds_read_b128 v[48:51], v162 offset:21504
    v_mfma_f32_16x16x32_bf16 v[32:35], v[72:75], v[96:99], v[32:35]
    ds_read_b128 v[52:55], v162 offset:22528
    v_mfma_f32_16x16x32_bf16 v[36:39], v[76:79], v[96:99], v[36:39]
    ds_read_b128 v[56:59], v162 offset:23552
    v_mfma_f32_16x16x32_bf16 v[40:43], v[80:83], v[96:99], v[40:43]
    ds_read_b128 v[60:63], v162 offset:24576
    s_waitcnt vmcnt(12)
    v_mfma_f32_16x16x32_bf16 v[4:7], v[64:67], v[92:95], v[4:7]
    v_mfma_f32_16x16x32_bf16 v[8:11], v[68:71], v[92:95], v[8:11]
    v_mfma_f32_16x16x32_bf16 v[12:15], v[72:75], v[92:95], v[12:15]
    v_mfma_f32_16x16x32_bf16 v[16:19], v[76:79], v[92:95], v[16:19]
    v_mfma_f32_16x16x32_bf16 v[20:23], v[80:83], v[92:95], v[20:23]
    s_waitcnt vmcnt(11) lgkmcnt(0)
    v_mfma_f32_16x16x32_bf16 v[24:27], v[44:47], v[104:107], v[24:27]
    ds_read_b128 v[64:67], v162 offset:30720
    v_mfma_f32_16x16x32_bf16 v[28:31], v[48:51], v[104:107], v[28:31]
    ds_read_b128 v[68:71], v162 offset:31744
    v_mfma_f32_16x16x32_bf16 v[32:35], v[52:55], v[104:107], v[32:35]
    ds_read_b128 v[72:75], v162 offset:32768
    v_mfma_f32_16x16x32_bf16 v[36:39], v[56:59], v[104:107], v[36:39]
    ds_read_b128 v[76:79], v162 offset:33792
    v_mfma_f32_16x16x32_bf16 v[40:43], v[60:63], v[104:107], v[40:43]
    ds_read_b128 v[80:83], v162 offset:34816
    s_waitcnt vmcnt(10)
    v_mfma_f32_16x16x32_bf16 v[4:7], v[44:47], v[100:103], v[4:7]
    v_mfma_f32_16x16x32_bf16 v[8:11], v[48:51], v[100:103], v[8:11]
    v_mfma_f32_16x16x32_bf16 v[12:15], v[52:55], v[100:103], v[12:15]
    v_mfma_f32_16x16x32_bf16 v[16:19], v[56:59], v[100:103], v[16:19]
    v_mfma_f32_16x16x32_bf16 v[20:23], v[60:63], v[100:103], v[20:23]
    s_waitcnt vmcnt(9) lgkmcnt(0)
    v_mfma_f32_16x16x32_bf16 v[24:27], v[64:67], v[112:115], v[24:27]
    s_barrier
    ds_read_b128 v[44:47], v162 offset:40960
    v_mfma_f32_16x16x32_bf16 v[28:31], v[68:71], v[112:115], v[28:31]
    ds_read_b128 v[48:51], v162 offset:41984
    v_mfma_f32_16x16x32_bf16 v[32:35], v[72:75], v[112:115], v[32:35]
    ds_read_b128 v[52:55], v162 offset:43008
    v_mfma_f32_16x16x32_bf16 v[36:39], v[76:79], v[112:115], v[36:39]
    ds_read_b128 v[56:59], v162 offset:44032
    v_mfma_f32_16x16x32_bf16 v[40:43], v[80:83], v[112:115], v[40:43]
    ds_read_b128 v[60:63], v162 offset:45056
    s_waitcnt vmcnt(8)
    v_mfma_f32_16x16x32_bf16 v[4:7], v[64:67], v[108:111], v[4:7]
    v_mfma_f32_16x16x32_bf16 v[8:11], v[68:71], v[108:111], v[8:11]
    v_mfma_f32_16x16x32_bf16 v[12:15], v[72:75], v[108:111], v[12:15]
    v_mfma_f32_16x16x32_bf16 v[16:19], v[76:79], v[108:111], v[16:19]
    v_mfma_f32_16x16x32_bf16 v[20:23], v[80:83], v[108:111], v[20:23]
    s_waitcnt vmcnt(7) lgkmcnt(0)
    v_mfma_f32_16x16x32_bf16 v[24:27], v[44:47], v[120:123], v[24:27]
    ds_read_b128 v[64:67], v162 offset:51200
    v_mfma_f32_16x16x32_bf16 v[28:31], v[48:51], v[120:123], v[28:31]
    ds_read_b128 v[68:71], v162 offset:52224
    v_mfma_f32_16x16x32_bf16 v[32:35], v[52:55], v[120:123], v[32:35]
    ds_read_b128 v[72:75], v162 offset:53248
    v_mfma_f32_16x16x32_bf16 v[36:39], v[56:59], v[120:123], v[36:39]
    ds_read_b128 v[76:79], v162 offset:54272
    v_mfma_f32_16x16x32_bf16 v[40:43], v[60:63], v[120:123], v[40:43]
    ds_read_b128 v[80:83], v162 offset:55296
    s_waitcnt vmcnt(6)
    v_mfma_f32_16x16x32_bf16 v[4:7], v[44:47], v[116:119], v[4:7]
    v_mfma_f32_16x16x32_bf16 v[8:11], v[48:51], v[116:119], v[8:11]
    v_mfma_f32_16x16x32_bf16 v[12:15], v[52:55], v[116:119], v[12:15]
    v_mfma_f32_16x16x32_bf16 v[16:19], v[56:59], v[116:119], v[16:19]
    v_mfma_f32_16x16x32_bf16 v[20:23], v[60:63], v[116:119], v[20:23]
    s_waitcnt vmcnt(5) lgkmcnt(0)
    v_mfma_f32_16x16x32_bf16 v[24:27], v[64:67], v[128:131], v[24:27]
    s_barrier
    ds_read_b128 v[44:47], v163 offset:0
    v_mfma_f32_16x16x32_bf16 v[28:31], v[68:71], v[128:131], v[28:31]
    ds_read_b128 v[48:51], v163 offset:1024
    v_mfma_f32_16x16x32_bf16 v[32:35], v[72:75], v[128:131], v[32:35]
    ds_read_b128 v[52:55], v163 offset:2048
    v_mfma_f32_16x16x32_bf16 v[36:39], v[76:79], v[128:131], v[36:39]
    ds_read_b128 v[56:59], v163 offset:3072
    v_mfma_f32_16x16x32_bf16 v[40:43], v[80:83], v[128:131], v[40:43]
    ds_read_b128 v[60:63], v163 offset:4096
    s_waitcnt vmcnt(4)
    v_mfma_f32_16x16x32_bf16 v[4:7], v[64:67], v[124:127], v[4:7]
    v_mfma_f32_16x16x32_bf16 v[8:11], v[68:71], v[124:127], v[8:11]
    v_mfma_f32_16x16x32_bf16 v[12:15], v[72:75], v[124:127], v[12:15]
    v_mfma_f32_16x16x32_bf16 v[16:19], v[76:79], v[124:127], v[16:19]
    v_mfma_f32_16x16x32_bf16 v[20:23], v[80:83], v[124:127], v[20:23]
    s_waitcnt vmcnt(3) lgkmcnt(0)
    v_mfma_f32_16x16x32_bf16 v[24:27], v[44:47], v[136:139], v[24:27]
    ds_read_b128 v[64:67], v163 offset:10240
    v_mfma_f32_16x16x32_bf16 v[28:31], v[48:51], v[136:139], v[28:31]
    ds_read_b128 v[68:71], v163 offset:11264
    v_mfma_f32_16x16x32_bf16 v[32:35], v[52:55], v[136:139], v[32:35]
    ds_read_b128 v[72:75], v163 offset:12288
    v_mfma_f32_16x16x32_bf16 v[36:39], v[56:59], v[136:139], v[36:39]
    ds_read_b128 v[76:79], v163 offset:13312
    v_mfma_f32_16x16x32_bf16 v[40:43], v[60:63], v[136:139], v[40:43]
    ds_read_b128 v[80:83], v163 offset:14336
    s_waitcnt vmcnt(2)
    v_mfma_f32_16x16x32_bf16 v[4:7], v[44:47], v[132:135], v[4:7]
    v_mfma_f32_16x16x32_bf16 v[8:11], v[48:51], v[132:135], v[8:11]
    v_mfma_f32_16x16x32_bf16 v[12:15], v[52:55], v[132:135], v[12:15]
    v_mfma_f32_16x16x32_bf16 v[16:19], v[56:59], v[132:135], v[16:19]
    v_mfma_f32_16x16x32_bf16 v[20:23], v[60:63], v[132:135], v[20:23]
    s_waitcnt vmcnt(1) lgkmcnt(0)
    v_mfma_f32_16x16x32_bf16 v[24:27], v[64:67], v[144:147], v[24:27]
    v_mfma_f32_16x16x32_bf16 v[28:31], v[68:71], v[144:147], v[28:31]
    v_mfma_f32_16x16x32_bf16 v[32:35], v[72:75], v[144:147], v[32:35]
    v_mfma_f32_16x16x32_bf16 v[36:39], v[76:79], v[144:147], v[36:39]
    v_mfma_f32_16x16x32_bf16 v[40:43], v[80:83], v[144:147], v[40:43]
    s_waitcnt vmcnt(0)
    v_mfma_f32_16x16x32_bf16 v[4:7], v[64:67], v[140:143], v[4:7]
    v_mfma_f32_16x16x32_bf16 v[8:11], v[68:71], v[140:143], v[8:11]
    v_mfma_f32_16x16x32_bf16 v[12:15], v[72:75], v[140:143], v[12:15]
    v_mfma_f32_16x16x32_bf16 v[16:19], v[76:79], v[140:143], v[16:19]
    v_mfma_f32_16x16x32_bf16 v[20:23], v[80:83], v[140:143], v[20:23]
    s_mul_i32 s21, s20, 5120
    s_add_u32 s21, s21, 81920
    v_add_u32 v162, s21, v2
    s_xor_b32 s21, s20, 1
    s_mul_i32 s21, s21, 5120
    s_add_u32 s21, s21, 81920
    v_add_u32 v163, s21, v2
    ds_write_b128 v162, v[24:27] offset:0
    ds_write_b128 v162, v[28:31] offset:1024
    ds_write_b128 v162, v[32:35] offset:2048
    ds_write_b128 v162, v[36:39] offset:3072
    ds_write_b128 v162, v[40:43] offset:4096
    v_lshlrev_b32 v44, 16, v148
    v_and_b32 v45, 0xffff0000, v148
    v_lshlrev_b32 v46, 16, v149
    v_and_b32 v47, 0xffff0000, v149
    v_lshlrev_b32 v48, 16, v150
    v_and_b32 v49, 0xffff0000, v150
    v_lshlrev_b32 v50, 16, v151
    v_and_b32 v51, 0xffff0000, v151
    v_lshlrev_b32 v52, 16, v152
    v_and_b32 v53, 0xffff0000, v152
    v_lshlrev_b32 v54, 16, v153
    v_and_b32 v55, 0xffff0000, v153
    v_lshlrev_b32 v56, 16, v154
    v_and_b32 v57, 0xffff0000, v154
    v_lshlrev_b32 v58, 16, v155
    v_and_b32 v59, 0xffff0000, v155
    v_lshlrev_b32 v60, 16, v156
    v_and_b32 v61, 0xffff0000, v156
    v_lshlrev_b32 v62, 16, v157
    v_and_b32 v63, 0xffff0000, v157
    v_pk_add_f32 v[44:45], v[44:45], v[4:5] op_sel:[0,0] op_sel_hi:[1,1]
    v_pk_add_f32 v[46:47], v[46:47], v[6:7] op_sel:[0,0] op_sel_hi:[1,1]
    v_pk_add_f32 v[48:49], v[48:49], v[8:9] op_sel:[0,0] op_sel_hi:[1,1]
    v_pk_add_f32 v[50:51], v[50:51], v[10:11] op_sel:[0,0] op_sel_hi:[1,1]
    v_pk_add_f32 v[52:53], v[52:53], v[12:13] op_sel:[0,0] op_sel_hi:[1,1]
    v_pk_add_f32 v[54:55], v[54:55], v[14:15] op_sel:[0,0] op_sel_hi:[1,1]
    v_pk_add_f32 v[56:57], v[56:57], v[16:17] op_sel:[0,0] op_sel_hi:[1,1]
    v_pk_add_f32 v[58:59], v[58:59], v[18:19] op_sel:[0,0] op_sel_hi:[1,1]
    v_pk_add_f32 v[60:61], v[60:61], v[20:21] op_sel:[0,0] op_sel_hi:[1,1]
    v_pk_add_f32 v[62:63], v[62:63], v[22:23] op_sel:[0,0] op_sel_hi:[1,1]
    s_waitcnt lgkmcnt(0)
    s_barrier
    ds_read_b128 v[24:27], v163 offset:0
    ds_read_b128 v[28:31], v163 offset:1024
    ds_read_b128 v[32:35], v163 offset:2048
    ds_read_b128 v[36:39], v163 offset:3072
    ds_read_b128 v[40:43], v163 offset:4096
    s_waitcnt lgkmcnt(4)
    v_pk_add_f32 v[44:45], v[44:45], v[24:25] op_sel:[0,0] op_sel_hi:[1,1]
    v_pk_add_f32 v[46:47], v[46:47], v[26:27] op_sel:[0,0] op_sel_hi:[1,1]
    s_waitcnt lgkmcnt(3)
    v_pk_add_f32 v[48:49], v[48:49], v[28:29] op_sel:[0,0] op_sel_hi:[1,1]
    v_pk_add_f32 v[50:51], v[50:51], v[30:31] op_sel:[0,0] op_sel_hi:[1,1]
    s_waitcnt lgkmcnt(2)
    v_pk_add_f32 v[52:53], v[52:53], v[32:33] op_sel:[0,0] op_sel_hi:[1,1]
    v_pk_add_f32 v[54:55], v[54:55], v[34:35] op_sel:[0,0] op_sel_hi:[1,1]
    s_waitcnt lgkmcnt(1)
    v_pk_add_f32 v[56:57], v[56:57], v[36:37] op_sel:[0,0] op_sel_hi:[1,1]
    v_pk_add_f32 v[58:59], v[58:59], v[38:39] op_sel:[0,0] op_sel_hi:[1,1]
    s_waitcnt lgkmcnt(0)
    v_pk_add_f32 v[60:61], v[60:61], v[40:41] op_sel:[0,0] op_sel_hi:[1,1]
    v_pk_add_f32 v[62:63], v[62:63], v[42:43] op_sel:[0,0] op_sel_hi:[1,1]
    v_cvt_pk_bf16_f32 v148, v44, v45
    v_cvt_pk_bf16_f32 v149, v46, v47
    v_cvt_pk_bf16_f32 v150, v48, v49
    v_cvt_pk_bf16_f32 v151, v50, v51
    v_cvt_pk_bf16_f32 v152, v52, v53
    v_cvt_pk_bf16_f32 v153, v54, v55
    v_cvt_pk_bf16_f32 v154, v56, v57
    v_cvt_pk_bf16_f32 v155, v58, v59
    v_cvt_pk_bf16_f32 v156, v60, v61
    v_cvt_pk_bf16_f32 v157, v62, v63
    buffer_store_dwordx4 v[148:151], v158, s[40:43], 0 offen
    buffer_store_dwordx4 v[152:155], v158, s[40:43], 0 offen offset:64
    buffer_store_dwordx2 v[156:157], v160, s[40:43], 0 offen offset:128
    s_endpgm
L_f_load:
    s_sub_u32 s31, s20, 4
    s_lshl_b32 s36, s31, 11
    s_mul_i32 s37, s31, 3072
    s_mul_i32 s38, s31, 5120
    s_mul_i32 s39, s31, 5120
    s_mul_i32 s32, s28, 245760
    s_add_u32 s32, s32, s37
    s_add_u32 s32, s32, 11304960
    s_mul_i32 s33, s26, 245760
    s_add_u32 s33, s33, 15237120
    s_lshl_b32 s34, s27, 2
    s_add_u32 s34, s34, s31
    s_lshl_b32 s22, s34, 11
    s_mul_i32 s34, s34, 40960
    s_add_u32 s34, s34, 17203200
    s_add_u32 s22, s22, 19824640
    v_bfe_u32 v21, v1, 4, 1
    v_lshlrev_b32 v21, 10, v21
    v_lshrrev_b32 v20, 5, v1
    v_lshl_add_u32 v21, v20, 6, v21
    v_and_b32 v20, 15, v1
    v_lshl_add_u32 v21, v20, 2, v21
    v_add_u32 v21, s22, v21
    s_add_u32 s35, s33, 110592
    s_add_u32 s35, s35, s37
    buffer_load_dwordx4 v[124:127], v2, s[12:15], s35 offen offset:0 sc1
    buffer_load_dwordx4 v[128:131], v2, s[12:15], s35 offen offset:1024 sc1
    buffer_load_dwordx4 v[132:135], v2, s[12:15], s35 offen offset:2048 sc1
    s_lshr_b32 s23, s2, 5
    v_lshlrev_b32 v15, 10, v1
    s_lshl_b32 s23, s23, 7
    s_add_u32 s23, s23, 26345472
    v_mov_b32 v12, 163584
    v_mov_b32 v13, 1
    s_mov_b64 exec, 1
    s_waitcnt vmcnt(3)
    ds_add_rtn_u32 v14, v12, v13
    s_waitcnt lgkmcnt(0)
    v_readfirstlane_b32 s21, v14
    s_cmp_eq_u32 s21, 0
    s_cbranch_scc1 L_kf_fus_poll_20_0
    s_cmp_eq_u32 s21, 7
    s_cbranch_scc0 L_kf_fus_go_19
    s_mov_b32 exec_lo, 0xffffffff
    buffer_atomic_add v13, v15, s[12:15], s23 offen offset:0 sc1
    s_branch L_kf_fus_go_19
L_kf_fus_poll_20_0:
    s_mov_b32 s21, 16384
L_kf_fus_poll_20:
    buffer_load_dword v14, off, s[12:15], s24 offset:0 sc1
    s_sub_u32 s21, s21, 1
    s_waitcnt vmcnt(0)
    v_cmp_ne_u32 vcc, 32, v14
    s_cmp_eq_u32 s21, 0
    s_cbranch_scc1 L_kf_fus_go_19
    s_cbranch_vccnz L_kf_fus_poll_20
L_kf_fus_go_19:
    s_mov_b64 exec, -1
    s_barrier
    s_lshl_b32 s21, s31, 8
    v_lshl_add_u32 v20, v1, 2, s21
    s_mul_i32 s21, s28, 768
    s_add_u32 s21, s21, 26247168
    buffer_load_dword v4, v20, s[12:15], s21 offen sc1
    s_add_u32 s21, s21, 12288
    buffer_load_dword v5, v20, s[12:15], s21 offen sc1
    s_add_u32 s21, s21, 12288
    buffer_load_dword v6, v20, s[12:15], s21 offen sc1
    s_add_u32 s21, s21, 12288
    buffer_load_dword v7, v20, s[12:15], s21 offen sc1
    s_add_u32 s21, s21, 12288
    buffer_load_dword v8, v20, s[12:15], s21 offen sc1
    s_add_u32 s21, s21, 12288
    buffer_load_dword v9, v20, s[12:15], s21 offen sc1
    s_add_u32 s21, s21, 12288
    buffer_load_dword v10, v20, s[12:15], s21 offen sc1
    s_add_u32 s21, s21, 12288
    buffer_load_dword v11, v20, s[12:15], s21 offen sc1
    s_waitcnt vmcnt(0)
    v_add_f32 v4, v4, v5
    v_add_f32 v4, v4, v6
    v_add_f32 v4, v4, v7
    v_add_f32 v4, v4, v8
    v_add_f32 v4, v4, v9
    v_add_f32 v4, v4, v10
    v_add_f32 v4, v4, v11
    v_add_u32 v20, 161536, v20
    ds_write_b32 v20, v4
    s_add_u32 s35, s33, 122880
    s_add_u32 s35, s35, s39
    buffer_load_dwordx4 v[136:139], v2, s[12:15], s35 offen offset:0 sc1
    buffer_load_dwordx4 v[140:143], v2, s[12:15], s35 offen offset:1024 sc1
    buffer_load_dwordx4 v[144:147], v2, s[12:15], s35 offen offset:2048 sc1
    buffer_load_dwordx4 v[148:151], v2, s[12:15], s35 offen offset:3072 sc1
    s_add_u32 s35, s33, 126976
    s_add_u32 s35, s35, s39
    buffer_load_dwordx4 v[152:155], v2, s[12:15], s35 offen offset:0 sc1
    s_add_u32 s35, s33, 143360
    s_add_u32 s35, s35, s38
    buffer_load_dwordx4 v[24:27], v2, s[12:15], s35 offen offset:0 sc1
    buffer_load_dwordx4 v[28:31], v2, s[12:15], s35 offen offset:1024 sc1
    buffer_load_dwordx4 v[32:35], v2, s[12:15], s35 offen offset:2048 sc1
    buffer_load_dwordx4 v[36:39], v2, s[12:15], s35 offen offset:3072 sc1
    s_add_u32 s35, s33, 147456
    s_add_u32 s35, s35, s38
    buffer_load_dwordx4 v[40:43], v2, s[12:15], s35 offen offset:0 sc1
    s_add_u32 s35, s33, 163840
    s_add_u32 s35, s35, s38
    buffer_load_dwordx4 v[44:47], v2, s[12:15], s35 offen offset:0 sc1
    buffer_load_dwordx4 v[48:51], v2, s[12:15], s35 offen offset:1024 sc1
    buffer_load_dwordx4 v[52:55], v2, s[12:15], s35 offen offset:2048 sc1
    buffer_load_dwordx4 v[56:59], v2, s[12:15], s35 offen offset:3072 sc1
    s_add_u32 s35, s33, 167936
    s_add_u32 s35, s35, s38
    buffer_load_dwordx4 v[60:63], v2, s[12:15], s35 offen offset:0 sc1
    s_add_u32 s35, s33, 184320
    s_add_u32 s35, s35, s38
    buffer_load_dwordx4 v[64:67], v2, s[12:15], s35 offen offset:0 sc1
    buffer_load_dwordx4 v[68:71], v2, s[12:15], s35 offen offset:1024 sc1
    buffer_load_dwordx4 v[72:75], v2, s[12:15], s35 offen offset:2048 sc1
    buffer_load_dwordx4 v[76:79], v2, s[12:15], s35 offen offset:3072 sc1
    s_add_u32 s35, s33, 188416
    s_add_u32 s35, s35, s38
    buffer_load_dwordx4 v[80:83], v2, s[12:15], s35 offen offset:0 sc1
    s_waitcnt lgkmcnt(0)
    s_barrier
    s_barrier
    s_add_u32 s35, s33, 204800
    s_add_u32 s35, s35, s38
    buffer_load_dwordx4 v[84:87], v2, s[12:15], s35 offen offset:0 sc1
    buffer_load_dwordx4 v[88:91], v2, s[12:15], s35 offen offset:1024 sc1
    buffer_load_dwordx4 v[92:95], v2, s[12:15], s35 offen offset:2048 sc1
    buffer_load_dwordx4 v[96:99], v2, s[12:15], s35 offen offset:3072 sc1
    s_add_u32 s35, s33, 208896
    s_add_u32 s35, s35, s38
    buffer_load_dwordx4 v[100:103], v2, s[12:15], s35 offen offset:0 sc1
    s_add_u32 s35, s33, 225280
    s_add_u32 s35, s35, s38
    buffer_load_dwordx4 v[104:107], v2, s[12:15], s35 offen offset:0 sc1
    buffer_load_dwordx4 v[108:111], v2, s[12:15], s35 offen offset:1024 sc1
    buffer_load_dwordx4 v[112:115], v2, s[12:15], s35 offen offset:2048 sc1
    buffer_load_dwordx4 v[116:119], v2, s[12:15], s35 offen offset:3072 sc1
    s_add_u32 s35, s33, 229376
    s_add_u32 s35, s35, s38
    buffer_load_dwordx4 v[120:123], v2, s[12:15], s35 offen offset:0 sc1
    s_barrier
    s_add_u32 m0, s36, 122880
    s_add_u32 s35, s34, 0
    buffer_load_dwordx4 v2, s[12:15], s35 offen offset:0 sc1 lds
    buffer_load_dwordx4 v2, s[12:15], s35 offen offset:1024 sc1 lds
    s_add_u32 m0, s36, 131072
    s_add_u32 s35, s34, 2048
    buffer_load_dwordx4 v2, s[12:15], s35 offen offset:0 sc1 lds
    buffer_load_dwordx4 v2, s[12:15], s35 offen offset:1024 sc1 lds
    s_add_u32 m0, s36, 139264
    s_add_u32 s35, s34, 4096
    buffer_load_dwordx4 v2, s[12:15], s35 offen offset:0 sc1 lds
    buffer_load_dwordx4 v2, s[12:15], s35 offen offset:1024 sc1 lds
    buffer_load_dword v12, v21, s[12:15], 0 offen offset:0 sc1
    buffer_load_dword v13, v21, s[12:15], 0 offen offset:128 sc1
    buffer_load_dword v14, v21, s[12:15], 0 offen offset:256 sc1
    buffer_load_dword v15, v21, s[12:15], 0 offen offset:384 sc1
    buffer_load_dword v16, v21, s[12:15], 0 offen offset:512 sc1
    buffer_load_dword v17, v21, s[12:15], 0 offen offset:640 sc1
    buffer_load_dword v18, v21, s[12:15], 0 offen offset:768 sc1
    buffer_load_dword v19, v21, s[12:15], 0 offen offset:896 sc1
    s_add_u32 s33, s33, s37
    s_waitcnt vmcnt(12)
    s_barrier
    s_add_u32 m0, s36, 147456
    s_add_u32 s35, s34, 6144
    buffer_load_dwordx4 v2, s[12:15], s35 offen offset:0 sc1 lds
    buffer_load_dwordx4 v2, s[12:15], s35 offen offset:1024 sc1 lds
    s_add_u32 m0, s37, 98304
    s_add_u32 s35, s32, 98304
    buffer_load_dwordx4 v2, s[12:15], s35 offen offset:0 sc1 lds
    buffer_load_dwordx4 v2, s[12:15], s35 offen offset:1024 sc1 lds
    buffer_load_dwordx4 v2, s[12:15], s35 offen offset:2048 sc1 lds
    s_waitcnt vmcnt(15)
    s_barrier
    s_add_u32 m0, s36, 122880
    s_add_u32 s35, s34, 8192
    buffer_load_dwordx4 v2, s[12:15], s35 offen offset:0 sc1 lds
    buffer_load_dwordx4 v2, s[12:15], s35 offen offset:1024 sc1 lds
    s_add_u32 m0, s37, 110592
    s_add_u32 s35, s32, 110592
    buffer_load_dwordx4 v2, s[12:15], s35 offen offset:0 sc1 lds
    buffer_load_dwordx4 v2, s[12:15], s35 offen offset:1024 sc1 lds
    buffer_load_dwordx4 v2, s[12:15], s35 offen offset:2048 sc1 lds
    s_waitcnt vmcnt(18)
    s_barrier
    s_add_u32 m0, s36, 131072
    s_add_u32 s35, s34, 10240
    buffer_load_dwordx4 v2, s[12:15], s35 offen offset:0 sc1 lds
    buffer_load_dwordx4 v2, s[12:15], s35 offen offset:1024 sc1 lds
    s_add_u32 m0, s37, 0
    s_add_u32 s35, s32, 122880
    buffer_load_dwordx4 v2, s[12:15], s35 offen offset:0 sc1 lds
    buffer_load_dwordx4 v2, s[12:15], s35 offen offset:1024 sc1 lds
    buffer_load_dwordx4 v2, s[12:15], s35 offen offset:2048 sc1 lds
    s_waitcnt vmcnt(13)
    s_barrier
    s_add_u32 m0, s36, 139264
    s_add_u32 s35, s34, 12288
    buffer_load_dwordx4 v2, s[12:15], s35 offen offset:0 sc1 lds
    buffer_load_dwordx4 v2, s[12:15], s35 offen offset:1024 sc1 lds
    s_add_u32 m0, s37, 12288
    s_add_u32 s35, s32, 135168
    buffer_load_dwordx4 v2, s[12:15], s35 offen offset:0 sc1 lds
    buffer_load_dwordx4 v2, s[12:15], s35 offen offset:1024 sc1 lds
    buffer_load_dwordx4 v2, s[12:15], s35 offen offset:2048 sc1 lds
    s_waitcnt vmcnt(13)
    s_barrier
    s_add_u32 m0, s36, 147456
    s_add_u32 s35, s34, 14336
    buffer_load_dwordx4 v2, s[12:15], s35 offen offset:0 sc1 lds
    buffer_load_dwordx4 v2, s[12:15], s35 offen offset:1024 sc1 lds
    s_add_u32 m0, s37, 24576
    s_add_u32 s35, s32, 147456
    buffer_load_dwordx4 v2, s[12:15], s35 offen offset:0 sc1 lds
    buffer_load_dwordx4 v2, s[12:15], s35 offen offset:1024 sc1 lds
    buffer_load_dwordx4 v2, s[12:15], s35 offen offset:2048 sc1 lds
    v_add_f32 v12, v12, v13
    v_add_f32 v12, v12, v14
    v_add_f32 v12, v12, v15
    v_add_f32 v12, v12, v16
    v_add_f32 v12, v12, v17
    v_add_f32 v12, v12, v18
    v_add_f32 v12, v12, v19
    v_mov_b32 v13, v12
    v_and_b32 v20, 31, v1
    s_lshl_b32 s21, s31, 8
    s_add_u32 s21, s21, 162560
    v_permlane32_swap_b32 v12, v13
    v_lshl_add_u32 v20, v20, 3, s21
    s_nop 0
    v_mul_f32 v12, 0x3acccccd, v12
    v_mul_f32 v13, 0x3acccccd, v13
    v_fma_f32 v13, -v12, v12, v13
    v_max_f32 v13, 0, v13
    v_cvt_pk_bf16_f32 v14, v12, v13
    v_and_b32 v15, 0xffff0000, v14
    v_lshlrev_b32 v14, 16, v14
    v_add_f32 v15, 0x3727c5ac, v15
    v_sub_f32 v16, 0, v14
    v_cvt_pk_bf16_f32 v15, v15, v15
    v_and_b32 v15, 0xffff0000, v15
    v_sqrt_f32 v15, v15
    s_nop 0
    v_cvt_pk_bf16_f32 v15, v15, v15
    v_and_b32 v15, 0xffff0000, v15
    v_rcp_f32 v17, v15
    s_nop 0
    v_mul_f32 v17, v17, v17
    ds_write_b64 v20, v[16:17]
    s_waitcnt lgkmcnt(0)
    s_waitcnt vmcnt(13)
    s_barrier
    s_add_u32 m0, s36, 122880
    s_add_u32 s35, s34, 16384
    buffer_load_dwordx4 v2, s[12:15], s35 offen offset:0 sc1 lds
    buffer_load_dwordx4 v2, s[12:15], s35 offen offset:1024 sc1 lds
    s_add_u32 m0, s37, 36864
    s_add_u32 s35, s32, 159744
    buffer_load_dwordx4 v2, s[12:15], s35 offen offset:0 sc1 lds
    buffer_load_dwordx4 v2, s[12:15], s35 offen offset:1024 sc1 lds
    buffer_load_dwordx4 v2, s[12:15], s35 offen offset:2048 sc1 lds
    s_waitcnt vmcnt(13)
    s_barrier
    s_add_u32 m0, s36, 131072
    s_add_u32 s35, s34, 18432
    buffer_load_dwordx4 v2, s[12:15], s35 offen offset:0 sc1 lds
    buffer_load_dwordx4 v2, s[12:15], s35 offen offset:1024 sc1 lds
    s_add_u32 m0, s37, 49152
    s_add_u32 s35, s32, 172032
    buffer_load_dwordx4 v2, s[12:15], s35 offen offset:0 sc1 lds
    buffer_load_dwordx4 v2, s[12:15], s35 offen offset:1024 sc1 lds
    buffer_load_dwordx4 v2, s[12:15], s35 offen offset:2048 sc1 lds
    s_waitcnt vmcnt(13)
    s_barrier
    s_add_u32 m0, s36, 139264
    s_add_u32 s35, s34, 20480
    buffer_load_dwordx4 v2, s[12:15], s35 offen offset:0 sc1 lds
    buffer_load_dwordx4 v2, s[12:15], s35 offen offset:1024 sc1 lds
    s_add_u32 m0, s37, 61440
    s_add_u32 s35, s32, 184320
    buffer_load_dwordx4 v2, s[12:15], s35 offen offset:0 sc1 lds
    buffer_load_dwordx4 v2, s[12:15], s35 offen offset:1024 sc1 lds
    buffer_load_dwordx4 v2, s[12:15], s35 offen offset:2048 sc1 lds
    s_waitcnt vmcnt(13)
    s_barrier
    s_add_u32 m0, s36, 147456
    s_add_u32 s35, s34, 22528
    buffer_load_dwordx4 v2, s[12:15], s35 offen offset:0 sc1 lds
    buffer_load_dwordx4 v2, s[12:15], s35 offen offset:1024 sc1 lds
    s_add_u32 m0, s37, 73728
    s_add_u32 s35, s32, 196608
    buffer_load_dwordx4 v2, s[12:15], s35 offen offset:0 sc1 lds
    buffer_load_dwordx4 v2, s[12:15], s35 offen offset:1024 sc1 lds
    buffer_load_dwordx4 v2, s[12:15], s35 offen offset:2048 sc1 lds
    s_waitcnt vmcnt(13)
    s_barrier
    s_add_u32 m0, s36, 122880
    s_add_u32 s35, s34, 24576
    buffer_load_dwordx4 v2, s[12:15], s35 offen offset:0 sc1 lds
    buffer_load_dwordx4 v2, s[12:15], s35 offen offset:1024 sc1 lds
    s_add_u32 m0, s37, 86016
    s_add_u32 s35, s32, 208896
    buffer_load_dwordx4 v2, s[12:15], s35 offen offset:0 sc1 lds
    buffer_load_dwordx4 v2, s[12:15], s35 offen offset:1024 sc1 lds
    buffer_load_dwordx4 v2, s[12:15], s35 offen offset:2048 sc1 lds
    s_waitcnt vmcnt(13)
    s_barrier
    s_add_u32 m0, s36, 131072
    s_add_u32 s35, s34, 26624
    buffer_load_dwordx4 v2, s[12:15], s35 offen offset:0 sc1 lds
    buffer_load_dwordx4 v2, s[12:15], s35 offen offset:1024 sc1 lds
    s_add_u32 m0, s37, 98304
    s_add_u32 s35, s32, 221184
    buffer_load_dwordx4 v2, s[12:15], s35 offen offset:0 sc1 lds
    buffer_load_dwordx4 v2, s[12:15], s35 offen offset:1024 sc1 lds
    buffer_load_dwordx4 v2, s[12:15], s35 offen offset:2048 sc1 lds
    s_add_u32 m0, s37, 110592
    s_add_u32 s35, s32, 233472
    buffer_load_dwordx4 v2, s[12:15], s35 offen offset:0 sc1 lds
    s_waitcnt vmcnt(14)
    s_barrier
    s_add_u32 m0, s36, 139264
    s_add_u32 s35, s34, 28672
    buffer_load_dwordx4 v2, s[12:15], s35 offen offset:0 sc1 lds
    buffer_load_dwordx4 v2, s[12:15], s35 offen offset:1024 sc1 lds
    s_add_u32 m0, s37, 111616
    s_add_u32 s35, s32, 234496
    buffer_load_dwordx4 v2, s[12:15], s35 offen offset:0 sc1 lds
    buffer_load_dwordx4 v2, s[12:15], s35 offen offset:1024 sc1 lds
    s_add_u32 m0, s37, 0
    s_add_u32 s35, s33, 0
    buffer_load_dwordx4 v2, s[12:15], s35 offen offset:0 sc1 lds
    buffer_load_dwordx4 v2, s[12:15], s35 offen offset:1024 sc1 lds
    s_waitcnt vmcnt(15)
    s_barrier
    s_add_u32 m0, s36, 147456
    s_add_u32 s35, s34, 30720
    buffer_load_dwordx4 v2, s[12:15], s35 offen offset:0 sc1 lds
    buffer_load_dwordx4 v2, s[12:15], s35 offen offset:1024 sc1 lds
    s_add_u32 m0, s37, 2048
    s_add_u32 s35, s33, 2048
    buffer_load_dwordx4 v2, s[12:15], s35 offen offset:0 sc1 lds
    s_add_u32 m0, s37, 12288
    s_add_u32 s35, s33, 12288
    buffer_load_dwordx4 v2, s[12:15], s35 offen offset:0 sc1 lds
    buffer_load_dwordx4 v2, s[12:15], s35 offen offset:1024 sc1 lds
    buffer_load_dwordx4 v2, s[12:15], s35 offen offset:2048 sc1 lds
    s_waitcnt vmcnt(16)
    s_barrier
    s_add_u32 m0, s36, 122880
    s_add_u32 s35, s34, 32768
    buffer_load_dwordx4 v2, s[12:15], s35 offen offset:0 sc1 lds
    buffer_load_dwordx4 v2, s[12:15], s35 offen offset:1024 sc1 lds
    s_add_u32 m0, s37, 24576
    s_add_u32 s35, s33, 24576
    buffer_load_dwordx4 v2, s[12:15], s35 offen offset:0 sc1 lds
    buffer_load_dwordx4 v2, s[12:15], s35 offen offset:1024 sc1 lds
    buffer_load_dwordx4 v2, s[12:15], s35 offen offset:2048 sc1 lds
    s_waitcnt vmcnt(15)
    s_barrier
    s_add_u32 m0, s36, 131072
    s_add_u32 s35, s34, 34816
    buffer_load_dwordx4 v2, s[12:15], s35 offen offset:0 sc1 lds
    buffer_load_dwordx4 v2, s[12:15], s35 offen offset:1024 sc1 lds
    s_add_u32 m0, s37, 36864
    s_add_u32 s35, s33, 36864
    buffer_load_dwordx4 v2, s[12:15], s35 offen offset:0 sc1 lds
    buffer_load_dwordx4 v2, s[12:15], s35 offen offset:1024 sc1 lds
    buffer_load_dwordx4 v2, s[12:15], s35 offen offset:2048 sc1 lds
    s_waitcnt vmcnt(14)
    s_barrier
    s_add_u32 m0, s36, 139264
    s_add_u32 s35, s34, 36864
    buffer_load_dwordx4 v2, s[12:15], s35 offen offset:0 sc1 lds
    buffer_load_dwordx4 v2, s[12:15], s35 offen offset:1024 sc1 lds
    s_add_u32 m0, s37, 49152
    s_add_u32 s35, s33, 49152
    buffer_load_dwordx4 v2, s[12:15], s35 offen offset:0 sc1 lds
    buffer_load_dwordx4 v2, s[12:15], s35 offen offset:1024 sc1 lds
    buffer_load_dwordx4 v2, s[12:15], s35 offen offset:2048 sc1 lds
    s_waitcnt vmcnt(13)
    s_barrier
    s_add_u32 m0, s36, 147456
    s_add_u32 s35, s34, 38912
    buffer_load_dwordx4 v2, s[12:15], s35 offen offset:0 sc1 lds
    buffer_load_dwordx4 v2, s[12:15], s35 offen offset:1024 sc1 lds
    s_add_u32 m0, s37, 61440
    s_add_u32 s35, s33, 61440
    buffer_load_dwordx4 v2, s[12:15], s35 offen offset:0 sc1 lds
    buffer_load_dwordx4 v2, s[12:15], s35 offen offset:1024 sc1 lds
    buffer_load_dwordx4 v2, s[12:15], s35 offen offset:2048 sc1 lds
    s_waitcnt vmcnt(13)
    s_barrier
    s_add_u32 m0, s37, 73728
    s_add_u32 s35, s33, 73728
    buffer_load_dwordx4 v2, s[12:15], s35 offen offset:0 sc1 lds
    buffer_load_dwordx4 v2, s[12:15], s35 offen offset:1024 sc1 lds
    buffer_load_dwordx4 v2, s[12:15], s35 offen offset:2048 sc1 lds
    s_waitcnt vmcnt(11)
    s_barrier
    s_add_u32 m0, s37, 86016
    s_add_u32 s35, s33, 86016
    buffer_load_dwordx4 v2, s[12:15], s35 offen offset:0 sc1 lds
    buffer_load_dwordx4 v2, s[12:15], s35 offen offset:1024 sc1 lds
    buffer_load_dwordx4 v2, s[12:15], s35 offen offset:2048 sc1 lds
    s_waitcnt vmcnt(9)
    s_barrier
    s_add_u32 m0, s37, 98304
    s_add_u32 s35, s33, 98304
    buffer_load_dwordx4 v2, s[12:15], s35 offen offset:0 sc1 lds
    buffer_load_dwordx4 v2, s[12:15], s35 offen offset:1024 sc1 lds
    buffer_load_dwordx4 v2, s[12:15], s35 offen offset:2048 sc1 lds
    s_barrier
    s_sub_u32 s33, s33, s37
    s_add_u32 s34, s33, s39
    v_add_u32 v4, s37, v2
    v_add_u32 v4, 110592, v4
    v_add_u32 v20, s39, v2
    v_add_u32 v20, 122880, v20
    s_waitcnt vmcnt(63)
    ds_write_b128 v4, v[124:127] offset:0
    ds_write_b128 v4, v[128:131] offset:1024
    ds_write_b128 v4, v[132:135] offset:2048
    ds_write_b128 v20, v[136:139] offset:0
    ds_write_b128 v20, v[140:143] offset:1024
    ds_write_b128 v20, v[144:147] offset:2048
    ds_write_b128 v20, v[148:151] offset:3072
    ds_write_b128 v20, v[152:155] offset:4096
    s_add_u32 s33, s33, s38
    v_add_u32 v4, s38, v2
    v_add_u32 v20, 4096, v4
    v_add_u32 v21, 143360, v4
    s_barrier
    s_waitcnt vmcnt(63)
    ds_write_b128 v21, v[24:27] offset:0
    ds_write_b128 v21, v[28:31] offset:1024
    ds_write_b128 v21, v[32:35] offset:2048
    ds_write_b128 v21, v[36:39] offset:3072
    ds_write_b128 v21, v[40:43] offset:4096
    s_waitcnt vmcnt(0)
    s_waitcnt lgkmcnt(0)
    s_barrier
    s_waitcnt vmcnt(0)
    s_waitcnt lgkmcnt(0)
    s_barrier
    s_waitcnt vmcnt(63)
    ds_write_b128 v4, v[44:47] offset:0
    ds_write_b128 v4, v[48:51] offset:1024
    ds_write_b128 v4, v[52:55] offset:2048
    ds_write_b128 v4, v[56:59] offset:3072
    ds_write_b128 v4, v[60:63] offset:4096
    s_waitcnt vmcnt(0)
    s_waitcnt lgkmcnt(0)
    s_barrier
    s_waitcnt vmcnt(63)
    ds_write_b128 v20, v[64:67] offset:16384
    ds_write_b128 v20, v[68:71] offset:17408
    ds_write_b128 v20, v[72:75] offset:18432
    ds_write_b128 v20, v[76:79] offset:19456
    ds_write_b128 v20, v[80:83] offset:20480
    s_waitcnt vmcnt(0)
    s_waitcnt lgkmcnt(0)
    s_barrier
    s_waitcnt vmcnt(63)
    ds_write_b128 v20, v[84:87] offset:36864
    ds_write_b128 v20, v[88:91] offset:37888
    ds_write_b128 v20, v[92:95] offset:38912
    ds_write_b128 v20, v[96:99] offset:39936
    ds_write_b128 v20, v[100:103] offset:40960
    s_waitcnt vmcnt(0)
    s_waitcnt lgkmcnt(0)
    s_barrier
    s_waitcnt vmcnt(63)
    ds_write_b128 v20, v[104:107] offset:57344
    ds_write_b128 v20, v[108:111] offset:58368
    ds_write_b128 v20, v[112:115] offset:59392
    ds_write_b128 v20, v[116:119] offset:60416
    ds_write_b128 v20, v[120:123] offset:61440
    s_waitcnt vmcnt(0)
    s_waitcnt lgkmcnt(0)
    s_barrier
    s_waitcnt vmcnt(0)
    s_waitcnt lgkmcnt(0)
    s_barrier
    s_waitcnt vmcnt(0)
    s_waitcnt lgkmcnt(0)
    s_barrier
    s_waitcnt vmcnt(0)
    s_waitcnt lgkmcnt(0)
    s_barrier
    s_waitcnt vmcnt(0)
    s_waitcnt lgkmcnt(0)
    s_barrier
    s_waitcnt vmcnt(0)
    s_waitcnt lgkmcnt(0)
    s_barrier
    s_waitcnt vmcnt(0)
    s_waitcnt lgkmcnt(0)
    s_barrier
    s_endpgm
L_f_idle:
    v_lshlrev_b32 v2, 4, v1
    s_lshl_b32 s24, s2, 7
    s_add_u32 s24, s24, 26345472
    s_mov_b32 s14, 0x1930000
    s_mov_b32 s15, 0x20000
    s_mov_b32 s18, 256
    s_mov_b32 s19, 0x20000
    s_waitcnt lgkmcnt(0)
    s_mov_b64 s[12:13], s[10:11]
    s_mov_b64 s[16:17], s[8:9]
    s_cmp_lt_u32 s20, 6
    s_cbranch_scc1 L_f_idleu
    s_cmp_lg_u32 s20, 7
    s_cbranch_scc1 L_f_idle1
    s_lshl_b32 s21, s29, 11
    s_add_u32 s21, s21, 26345472
    v_mov_b32 v4, 0
    v_mov_b32 v5, 0
    v_mov_b32 v6, 0
    v_mov_b32 v7, 0
    v_mov_b32 v8, 1
    buffer_store_dwordx4 v[4:7], v2, s[12:15], s21 offen sc1
    buffer_store_dwordx4 v[4:7], v2, s[12:15], s21 offen offset:1024 sc1
    s_mov_b64 exec, 1
    s_waitcnt vmcnt(0)
    buffer_atomic_add v8, off, s[16:19], 0 sc1
    s_mov_b64 exec, -1
L_f_idle1:
    s_barrier
    s_barrier
    s_barrier
    s_barrier
    s_barrier
    s_barrier
    s_barrier
    s_barrier
    s_barrier
    s_barrier
    s_barrier
    s_branch L_att_pre
L_f_help:
    s_setprio 0
    v_lshlrev_b32 v2, 4, v1
    s_lshl_b32 s24, s2, 7
    s_add_u32 s24, s24, 26345472
    s_mov_b32 s14, 0x1930000
    s_mov_b32 s15, 0x20000
    s_mov_b32 s18, 256
    s_mov_b32 s19, 0x20000
    s_waitcnt lgkmcnt(0)
    s_mov_b64 s[12:13], s[10:11]
    s_mov_b64 s[16:17], s[8:9]
    s_and_b32 s25, s2, 7
    s_lshl_b32 s25, s25, 2
    s_bfe_u32 s21, s2, 0x20003
    s_add_u32 s25, s25, s21
    s_lshr_b32 s26, s2, 5
    s_and_b32 s27, s2, 1
    s_lshl_b32 s27, s27, 3
    s_bfe_u32 s21, s2, 0x30003
    s_add_u32 s27, s27, s21
    s_bfe_u32 s28, s2, 0x20001
    s_lshl_b32 s28, s28, 2
    s_lshr_b32 s21, s2, 6
    s_add_u32 s28, s28, s21
    s_barrier
    s_cmp_eq_u32 s20, 9
    s_cbranch_scc1 L_f_w9
    s_load_dwordx4 s[32:35], s[0:1], 32
    v_mov_b32 v32, 0
    v_mov_b32 v33, 0
    v_mov_b32 v34, 0
    v_mov_b32 v35, 0
    v_add_u32 v9, 163584, v2
    s_mov_b64 exec, 3
    ds_write_b128 v9, v[32:35]
    s_mov_b64 exec, -1
    s_lshr_b32 s36, s2, 3
    s_and_b32 s37, s2, 7
    v_lshrrev_b32 v4, 3, v1
    v_mul_u32_u24 v4, 3072, v4
    v_and_b32 v5, 7, v1
    v_lshl_add_u32 v8, v5, 4, v4
    s_mul_i32 s38, s37, 245760
    s_lshl_b32 s21, s36, 7
    s_add_u32 s38, s38, s21
    s_waitcnt lgkmcnt(0)
    s_mov_b32 s44, s32
    s_mov_b32 s45, s33
    s_mov_b32 s46, 0x1e0000
    s_mov_b32 s47, 0x20000
    s_mov_b32 s48, s34
    s_mov_b32 s49, s35
    s_mov_b32 s50, 0x1e0000
    s_mov_b32 s51, 0x20000
    s_cmp_ge_u32 s2, 192
    s_cbranch_scc1 L_f_h0
    s_barrier
    s_barrier
    s_barrier
    s_barrier
    s_barrier
    s_barrier
    s_barrier
    s_barrier
    s_mov_b32 m0, 98304
    s_nop 0
    buffer_load_dwordx4 v8, s[44:47], s38 offen  lds
    s_mov_b32 m0, 108544
    s_nop 0
    buffer_load_dwordx4 v8, s[48:51], s38 offen  lds
    s_add_u32 s38, s38, 24576
    s_mov_b32 m0, 99328
    s_nop 0
    buffer_load_dwordx4 v8, s[44:47], s38 offen  lds
    s_mov_b32 m0, 109568
    s_nop 0
    buffer_load_dwordx4 v8, s[48:51], s38 offen  lds
    s_add_u32 s38, s38, 24576
    s_mov_b32 m0, 100352
    s_nop 0
    buffer_load_dwordx4 v8, s[44:47], s38 offen  lds
    s_mov_b32 m0, 110592
    s_nop 0
    buffer_load_dwordx4 v8, s[48:51], s38 offen  lds
    s_add_u32 s38, s38, 24576
    s_mov_b32 m0, 101376
    s_nop 0
    buffer_load_dwordx4 v8, s[44:47], s38 offen  lds
    s_mov_b32 m0, 111616
    s_nop 0
    buffer_load_dwordx4 v8, s[48:51], s38 offen  lds
    s_add_u32 s38, s38, 24576
    s_mov_b32 m0, 102400
    s_nop 0
    buffer_load_dwordx4 v8, s[44:47], s38 offen  lds
    s_mov_b32 m0, 112640
    s_nop 0
    buffer_load_dwordx4 v8, s[48:51], s38 offen  lds
    s_add_u32 s38, s38, 24576
    s_mov_b32 m0, 103424
    s_nop 0
    buffer_load_dwordx4 v8, s[44:47], s38 offen  lds
    s_mov_b32 m0, 113664
    s_nop 0
    buffer_load_dwordx4 v8, s[48:51], s38 offen  lds
    s_add_u32 s38, s38, 24576
    s_mov_b32 m0, 104448
    s_nop 0
    buffer_load_dwordx4 v8, s[44:47], s38 offen  lds
    s_mov_b32 m0, 114688
    s_nop 0
    buffer_load_dwordx4 v8, s[48:51], s38 offen  lds
    s_add_u32 s38, s38, 24576
    s_mov_b32 m0, 105472
    s_nop 0
    buffer_load_dwordx4 v8, s[44:47], s38 offen  lds
    s_mov_b32 m0, 115712
    s_nop 0
    buffer_load_dwordx4 v8, s[48:51], s38 offen  lds
    s_add_u32 s38, s38, 24576
    s_mov_b32 m0, 106496
    s_nop 0
    buffer_load_dwordx4 v8, s[44:47], s38 offen  lds
    s_mov_b32 m0, 116736
    s_nop 0
    buffer_load_dwordx4 v8, s[48:51], s38 offen  lds
    s_add_u32 s38, s38, 24576
    s_mov_b32 m0, 107520
    s_nop 0
    buffer_load_dwordx4 v8, s[44:47], s38 offen  lds
    s_mov_b32 m0, 117760
    s_nop 0
    buffer_load_dwordx4 v8, s[48:51], s38 offen  lds
    s_add_u32 s38, s38, 24576
    s_barrier
    v_bfe_u32 v4, v1, 1, 1
    v_mul_u32_u24 v4, 10240, v4
    v_bfe_u32 v5, v1, 4, 1
    v_lshl_add_u32 v4, v5, 4, v4
    v_and_b32 v5, 1, v1
    v_lshl_add_u32 v4, v5, 3, v4
    v_bfe_u32 v5, v1, 2, 2
    v_lshl_add_u32 v4, v5, 7, v4
    v_add_u32 v4, 98304, v4
    v_lshrrev_b32 v5, 5, v1
    v_lshl_add_u32 v10, v5, 10, v4
    v_lshlrev_b32 v11, 4, v1
    v_mov_b32 v12, 0x3f803f80
    v_mov_b32 v13, 0x3f803f80
    s_barrier
    s_lshl_b32 s21, s36, 2
    s_add_u32 s21, s21, 0
    s_mul_i32 s22, s21, 43
    s_lshr_b32 s22, s22, 8
    s_mul_i32 s22, s22, 239616
    s_lshl_b32 s21, s21, 10
    s_add_u32 s21, s21, s22
    s_mul_i32 s22, s37, 30720
    s_add_u32 s21, s21, s22
    s_add_u32 s39, s21, 11304960
    s_lshl_b32 s21, s36, 2
    s_add_u32 s21, s21, 1
    s_mul_i32 s22, s21, 43
    s_lshr_b32 s22, s22, 8
    s_mul_i32 s22, s22, 239616
    s_lshl_b32 s21, s21, 10
    s_add_u32 s21, s21, s22
    s_mul_i32 s22, s37, 30720
    s_add_u32 s21, s21, s22
    s_add_u32 s40, s21, 11304960
    s_lshl_b32 s21, s36, 2
    s_add_u32 s21, s21, 2
    s_mul_i32 s22, s21, 43
    s_lshr_b32 s22, s22, 8
    s_mul_i32 s22, s22, 239616
    s_lshl_b32 s21, s21, 10
    s_add_u32 s21, s21, s22
    s_mul_i32 s22, s37, 30720
    s_add_u32 s21, s21, s22
    s_add_u32 s41, s21, 11304960
    s_lshl_b32 s21, s36, 2
    s_add_u32 s21, s21, 3
    s_mul_i32 s22, s21, 43
    s_lshr_b32 s22, s22, 8
    s_mul_i32 s22, s22, 239616
    s_lshl_b32 s21, s21, 10
    s_add_u32 s21, s21, s22
    s_mul_i32 s22, s37, 30720
    s_add_u32 s21, s21, s22
    s_add_u32 s42, s21, 11304960
    s_barrier
    s_waitcnt vmcnt(0)
    ds_read_b64_tr_b16 v[32:33], v10 offset:0
    ds_read_b64_tr_b16 v[34:35], v10 offset:512
    ds_read_b64_tr_b16 v[36:37], v10 offset:32
    ds_read_b64_tr_b16 v[38:39], v10 offset:544
    ds_read_b64_tr_b16 v[40:41], v10 offset:64
    ds_read_b64_tr_b16 v[42:43], v10 offset:576
    ds_read_b64_tr_b16 v[44:45], v10 offset:96
    ds_read_b64_tr_b16 v[46:47], v10 offset:608
    ds_read_b64_tr_b16 v[48:49], v10 offset:2048
    ds_read_b64_tr_b16 v[50:51], v10 offset:2560
    ds_read_b64_tr_b16 v[52:53], v10 offset:2080
    ds_read_b64_tr_b16 v[54:55], v10 offset:2592
    ds_read_b64_tr_b16 v[56:57], v10 offset:2112
    ds_read_b64_tr_b16 v[58:59], v10 offset:2624
    ds_read_b64_tr_b16 v[60:61], v10 offset:2144
    ds_read_b64_tr_b16 v[62:63], v10 offset:2656
    s_waitcnt lgkmcnt(8)
    buffer_store_dwordx4 v[32:35], v11, s[12:15], s39 offen sc1
    s_add_u32 s39, s39, 6144
    buffer_store_dwordx4 v[36:39], v11, s[12:15], s40 offen sc1
    s_add_u32 s40, s40, 6144
    buffer_store_dwordx4 v[40:43], v11, s[12:15], s41 offen sc1
    s_add_u32 s41, s41, 6144
    buffer_store_dwordx4 v[44:47], v11, s[12:15], s42 offen sc1
    s_add_u32 s42, s42, 6144
    v_mfma_f32_4x4x4_16b_bf16 v[16:19], v[12:13], v[32:33], 0
    v_mfma_f32_4x4x4_16b_bf16 v[20:23], v[12:13], v[36:37], 0
    v_mfma_f32_4x4x4_16b_bf16 v[24:27], v[12:13], v[40:41], 0
    v_mfma_f32_4x4x4_16b_bf16 v[28:31], v[12:13], v[44:45], 0
    v_mfma_f32_4x4x4_16b_bf16 v[16:19], v[12:13], v[34:35], v[16:19]
    v_mfma_f32_4x4x4_16b_bf16 v[20:23], v[12:13], v[38:39], v[20:23]
    v_mfma_f32_4x4x4_16b_bf16 v[24:27], v[12:13], v[42:43], v[24:27]
    v_mfma_f32_4x4x4_16b_bf16 v[28:31], v[12:13], v[46:47], v[28:31]
    s_waitcnt lgkmcnt(0)
    buffer_store_dwordx4 v[48:51], v11, s[12:15], s39 offen sc1
    s_add_u32 s39, s39, 6144
    buffer_store_dwordx4 v[52:55], v11, s[12:15], s40 offen sc1
    s_add_u32 s40, s40, 6144
    buffer_store_dwordx4 v[56:59], v11, s[12:15], s41 offen sc1
    s_add_u32 s41, s41, 6144
    buffer_store_dwordx4 v[60:63], v11, s[12:15], s42 offen sc1
    s_add_u32 s42, s42, 6144
    v_mfma_f32_4x4x4_16b_bf16 v[16:19], v[12:13], v[48:49], v[16:19]
    v_mfma_f32_4x4x4_16b_bf16 v[20:23], v[12:13], v[52:53], v[20:23]
    v_mfma_f32_4x4x4_16b_bf16 v[24:27], v[12:13], v[56:57], v[24:27]
    v_mfma_f32_4x4x4_16b_bf16 v[28:31], v[12:13], v[60:61], v[28:31]
    v_mfma_f32_4x4x4_16b_bf16 v[16:19], v[12:13], v[50:51], v[16:19]
    v_mfma_f32_4x4x4_16b_bf16 v[20:23], v[12:13], v[54:55], v[20:23]
    v_mfma_f32_4x4x4_16b_bf16 v[24:27], v[12:13], v[58:59], v[24:27]
    v_mfma_f32_4x4x4_16b_bf16 v[28:31], v[12:13], v[62:63], v[28:31]
    ds_read_b64_tr_b16 v[64:65], v10 offset:4096
    ds_read_b64_tr_b16 v[66:67], v10 offset:4608
    ds_read_b64_tr_b16 v[68:69], v10 offset:4128
    ds_read_b64_tr_b16 v[70:71], v10 offset:4640
    ds_read_b64_tr_b16 v[72:73], v10 offset:4160
    ds_read_b64_tr_b16 v[74:75], v10 offset:4672
    ds_read_b64_tr_b16 v[76:77], v10 offset:4192
    ds_read_b64_tr_b16 v[78:79], v10 offset:4704
    ds_read_b64_tr_b16 v[80:81], v10 offset:6144
    ds_read_b64_tr_b16 v[82:83], v10 offset:6656
    ds_read_b64_tr_b16 v[84:85], v10 offset:6176
    ds_read_b64_tr_b16 v[86:87], v10 offset:6688
    ds_read_b64_tr_b16 v[88:89], v10 offset:6208
    ds_read_b64_tr_b16 v[90:91], v10 offset:6720
    ds_read_b64_tr_b16 v[92:93], v10 offset:6240
    ds_read_b64_tr_b16 v[94:95], v10 offset:6752
    s_waitcnt lgkmcnt(8)
    buffer_store_dwordx4 v[64:67], v11, s[12:15], s39 offen sc1
    s_add_u32 s39, s39, 6144
    buffer_store_dwordx4 v[68:71], v11, s[12:15], s40 offen sc1
    s_add_u32 s40, s40, 6144
    buffer_store_dwordx4 v[72:75], v11, s[12:15], s41 offen sc1
    s_add_u32 s41, s41, 6144
    buffer_store_dwordx4 v[76:79], v11, s[12:15], s42 offen sc1
    s_add_u32 s42, s42, 6144
    v_mfma_f32_4x4x4_16b_bf16 v[16:19], v[12:13], v[64:65], v[16:19]
    v_mfma_f32_4x4x4_16b_bf16 v[20:23], v[12:13], v[68:69], v[20:23]
    v_mfma_f32_4x4x4_16b_bf16 v[24:27], v[12:13], v[72:73], v[24:27]
    v_mfma_f32_4x4x4_16b_bf16 v[28:31], v[12:13], v[76:77], v[28:31]
    v_mfma_f32_4x4x4_16b_bf16 v[16:19], v[12:13], v[66:67], v[16:19]
    v_mfma_f32_4x4x4_16b_bf16 v[20:23], v[12:13], v[70:71], v[20:23]
    v_mfma_f32_4x4x4_16b_bf16 v[24:27], v[12:13], v[74:75], v[24:27]
    v_mfma_f32_4x4x4_16b_bf16 v[28:31], v[12:13], v[78:79], v[28:31]
    s_waitcnt lgkmcnt(0)
    buffer_store_dwordx4 v[80:83], v11, s[12:15], s39 offen sc1
    s_add_u32 s39, s39, 6144
    buffer_store_dwordx4 v[84:87], v11, s[12:15], s40 offen sc1
    s_add_u32 s40, s40, 6144
    buffer_store_dwordx4 v[88:91], v11, s[12:15], s41 offen sc1
    s_add_u32 s41, s41, 6144
    buffer_store_dwordx4 v[92:95], v11, s[12:15], s42 offen sc1
    s_add_u32 s42, s42, 6144
    v_mfma_f32_4x4x4_16b_bf16 v[16:19], v[12:13], v[80:81], v[16:19]
    v_mfma_f32_4x4x4_16b_bf16 v[20:23], v[12:13], v[84:85], v[20:23]
    v_mfma_f32_4x4x4_16b_bf16 v[24:27], v[12:13], v[88:89], v[24:27]
    v_mfma_f32_4x4x4_16b_bf16 v[28:31], v[12:13], v[92:93], v[28:31]
    v_mfma_f32_4x4x4_16b_bf16 v[16:19], v[12:13], v[82:83], v[16:19]
    v_mfma_f32_4x4x4_16b_bf16 v[20:23], v[12:13], v[86:87], v[20:23]
    v_mfma_f32_4x4x4_16b_bf16 v[24:27], v[12:13], v[90:91], v[24:27]
    v_mfma_f32_4x4x4_16b_bf16 v[28:31], v[12:13], v[94:95], v[28:31]
    ds_read_b64_tr_b16 v[96:97], v10 offset:8192
    ds_read_b64_tr_b16 v[98:99], v10 offset:8704
    ds_read_b64_tr_b16 v[100:101], v10 offset:8224
    ds_read_b64_tr_b16 v[102:103], v10 offset:8736
    ds_read_b64_tr_b16 v[104:105], v10 offset:8256
    ds_read_b64_tr_b16 v[106:107], v10 offset:8768
    ds_read_b64_tr_b16 v[108:109], v10 offset:8288
    ds_read_b64_tr_b16 v[110:111], v10 offset:8800
    s_waitcnt lgkmcnt(0)
    buffer_store_dwordx4 v[96:99], v11, s[12:15], s39 offen sc1
    buffer_store_dwordx4 v[100:103], v11, s[12:15], s40 offen sc1
    buffer_store_dwordx4 v[104:107], v11, s[12:15], s41 offen sc1
    buffer_store_dwordx4 v[108:111], v11, s[12:15], s42 offen sc1
    v_mfma_f32_4x4x4_16b_bf16 v[16:19], v[12:13], v[96:97], v[16:19]
    v_mfma_f32_4x4x4_16b_bf16 v[20:23], v[12:13], v[100:101], v[20:23]
    v_mfma_f32_4x4x4_16b_bf16 v[24:27], v[12:13], v[104:105], v[24:27]
    v_mfma_f32_4x4x4_16b_bf16 v[28:31], v[12:13], v[108:109], v[28:31]
    v_mfma_f32_4x4x4_16b_bf16 v[16:19], v[12:13], v[98:99], v[16:19]
    v_mfma_f32_4x4x4_16b_bf16 v[20:23], v[12:13], v[102:103], v[20:23]
    v_mfma_f32_4x4x4_16b_bf16 v[24:27], v[12:13], v[106:107], v[24:27]
    v_mfma_f32_4x4x4_16b_bf16 v[28:31], v[12:13], v[110:111], v[28:31]
    s_mul_i32 s21, s37, 12288
    s_lshl_b32 s22, s36, 9
    s_add_u32 s21, s21, s22
    s_add_u32 s21, s21, 26247168
    v_lshlrev_b32 v11, 2, v1
    s_nop 1
    v_permlane32_swap_b32 v16, v17
    v_permlane32_swap_b32 v20, v21
    v_permlane32_swap_b32 v24, v25
    v_permlane32_swap_b32 v28, v29
    s_mov_b32 exec_hi, 0
    v_add_f32 v16, v16, v17
    buffer_store_dword v16, v11, s[12:15], s21 offen offset:0 sc1
    v_add_f32 v20, v20, v21
    buffer_store_dword v20, v11, s[12:15], s21 offen offset:128 sc1
    v_add_f32 v24, v24, v25
    buffer_store_dword v24, v11, s[12:15], s21 offen offset:256 sc1
    v_add_f32 v28, v28, v29
    buffer_store_dword v28, v11, s[12:15], s21 offen offset:384 sc1
    s_branch L_f_hsig
L_f_idleu:
    s_mul_i32 s31, s29, 6
    s_add_u32 s31, s31, s20
    s_load_dwordx2 s[32:33], s[0:1], 48
    s_load_dwordx2 s[34:35], s[0:1], 16
    s_and_b32 s44, s31, 1
    s_lshr_b32 s31, s31, 1
    v_add_u32 v8, 4096, v2
    s_mul_i32 s43, s20, 20480
    s_waitcnt lgkmcnt(0)
    s_cmp_ge_u32 s31, 48
    s_cbranch_scc1 L_kf_fus_wo_21
    s_mul_i32 s36, s31, 40960
    s_mov_b32 s37, 20480
    s_mov_b32 s38, 10240
    s_mov_b32 s39, 0
    s_mul_i32 s40, s31, 5120
    s_add_u32 s40, s40, 15237120
    s_mov_b32 s41, 245760
    s_mov_b32 s42, 1966080
    s_branch L_kf_fus_dwgo_22
L_kf_fus_wo_21:
    s_mov_b64 s[32:33], s[34:35]
    s_sub_u32 s31, s31, 48
    s_mul_i32 s40, s31, 5120
    s_add_u32 s40, s40, 10485760
    s_mov_b32 s41, 102400
    s_mov_b32 s42, 819200
    s_mul_i32 s36, s31, 51200
    s_mov_b32 s37, 25600
    s_mov_b32 s38, 10240
    s_mov_b32 s39, 0
    s_cmp_lt_u32 s31, 16
    s_cbranch_scc1 L_kf_fus_dwgo_22
    s_mul_i32 s36, s31, 204800
    s_sub_u32 s36, s36, 3256320
    s_mov_b32 s37, 102400
    s_mov_b32 s38, 25600
    s_mov_b32 s39, 46080
L_kf_fus_dwgo_22:
    s_mul_i32 s21, s44, 640
    s_add_u32 s36, s36, s21
    s_mul_i32 s21, s44, s41
    s_lshl2_add_u32 s40, s21, s40
    s_mov_b32 s48, s32
    s_mov_b32 s49, s33
    s_mov_b32 s50, 0x0
    s_mov_b32 s51, 0x20000
    s_mov_b32 s50, s42
    v_add_u32 v4, 0, v1
    v_mul_u32_u24 v4, 1639, v4
    v_lshrrev_b32 v4, 16, v4
    v_mul_u32_u24 v5, 640, v4
    v_add_u32 v5, v5, v2
    v_lshrrev_b32 v4, 2, v4
    v_mad_u32_u24 v11, v4, s39, v5
    v_add_u32 v4, 64, v1
    v_mul_u32_u24 v4, 1639, v4
    v_lshrrev_b32 v4, 16, v4
    v_mul_u32_u24 v5, 640, v4
    v_add_u32 v5, v5, v2
    v_lshrrev_b32 v4, 2, v4
    v_mad_u32_u24 v12, v4, s39, v5
    v_add_u32 v4, 128, v1
    v_mul_u32_u24 v4, 1639, v4
    v_lshrrev_b32 v4, 16, v4
    v_mul_u32_u24 v5, 640, v4
    v_add_u32 v5, v5, v2
    v_lshrrev_b32 v4, 2, v4
    v_mad_u32_u24 v13, v4, s39, v5
    v_add_u32 v4, 192, v1
    v_mul_u32_u24 v4, 1639, v4
    v_lshrrev_b32 v4, 16, v4
    v_mul_u32_u24 v5, 640, v4
    v_add_u32 v5, v5, v2
    v_lshrrev_b32 v4, 2, v4
    v_mad_u32_u24 v14, v4, s39, v5
    v_add_u32 v4, 256, v1
    v_mul_u32_u24 v4, 1639, v4
    v_lshrrev_b32 v4, 16, v4
    v_mul_u32_u24 v5, 640, v4
    v_add_u32 v5, v5, v8
    v_lshrrev_b32 v4, 2, v4
    v_mad_u32_u24 v15, v4, s39, v5
    s_mov_b32 s21, s36
    s_add_u32 m0, s43, 0
    s_nop 0
    buffer_load_dwordx4 v11, s[48:51], s21 offen offset:0  lds
    buffer_load_dwordx4 v12, s[48:51], s21 offen offset:1024  lds
    buffer_load_dwordx4 v13, s[48:51], s21 offen offset:2048  lds
    buffer_load_dwordx4 v14, s[48:51], s21 offen offset:3072  lds
    s_add_u32 m0, s43, 4096
    s_nop 0
    buffer_load_dwordx4 v15, s[48:51], s21 offen  lds
    s_mov_b32 s21, s36
    s_add_u32 s21, s21, s38
    s_add_u32 m0, s43, 5120
    s_nop 0
    buffer_load_dwordx4 v11, s[48:51], s21 offen offset:0  lds
    buffer_load_dwordx4 v12, s[48:51], s21 offen offset:1024  lds
    buffer_load_dwordx4 v13, s[48:51], s21 offen offset:2048  lds
    buffer_load_dwordx4 v14, s[48:51], s21 offen offset:3072  lds
    s_add_u32 m0, s43, 9216
    s_nop 0
    buffer_load_dwordx4 v15, s[48:51], s21 offen  lds
    s_mov_b32 s21, s36
    s_add_u32 s21, s21, s37
    s_add_u32 m0, s43, 10240
    s_nop 0
    buffer_load_dwordx4 v11, s[48:51], s21 offen offset:0  lds
    buffer_load_dwordx4 v12, s[48:51], s21 offen offset:1024  lds
    buffer_load_dwordx4 v13, s[48:51], s21 offen offset:2048  lds
    buffer_load_dwordx4 v14, s[48:51], s21 offen offset:3072  lds
    s_add_u32 m0, s43, 14336
    s_nop 0
    buffer_load_dwordx4 v15, s[48:51], s21 offen  lds
    s_mov_b32 s21, s36
    s_add_u32 s21, s21, s37
    s_add_u32 s21, s21, s38
    s_add_u32 m0, s43, 15360
    s_nop 0
    buffer_load_dwordx4 v11, s[48:51], s21 offen offset:0  lds
    buffer_load_dwordx4 v12, s[48:51], s21 offen offset:1024  lds
    buffer_load_dwordx4 v13, s[48:51], s21 offen offset:2048  lds
    buffer_load_dwordx4 v14, s[48:51], s21 offen offset:3072  lds
    s_add_u32 m0, s43, 19456
    s_nop 0
    buffer_load_dwordx4 v15, s[48:51], s21 offen  lds
    v_lshrrev_b32 v4, 5, v1
    v_lshlrev_b32 v4, 4, v4
    v_bfe_u32 v5, v1, 2, 3
    v_add_u32 v4, v4, v5
    v_mul_u32_u24 v4, 640, v4
    v_and_b32 v5, 3, v1
    v_add_u32 v4, s43, v4
    v_lshl_add_u32 v9, v5, 4, v4
    v_lshl_add_u32 v10, v5, 3, v4
    s_waitcnt vmcnt(0)
    ds_read_b64_tr_b16 v[16:17], v9 offset:0
    ds_read_b64_tr_b16 v[18:19], v9 offset:5120
    ds_read_b64_tr_b16 v[20:21], v9 offset:8
    ds_read_b64_tr_b16 v[22:23], v9 offset:5128
    ds_read_b64_tr_b16 v[24:25], v9 offset:64
    ds_read_b64_tr_b16 v[26:27], v9 offset:5184
    ds_read_b64_tr_b16 v[28:29], v9 offset:72
    ds_read_b64_tr_b16 v[30:31], v9 offset:5192
    ds_read_b64_tr_b16 v[32:33], v10 offset:128
    ds_read_b64_tr_b16 v[34:35], v10 offset:5248
    ds_read_b64_tr_b16 v[36:37], v9 offset:160
    ds_read_b64_tr_b16 v[38:39], v9 offset:5280
    ds_read_b64_tr_b16 v[40:41], v9 offset:168
    ds_read_b64_tr_b16 v[42:43], v9 offset:5288
    ds_read_b64_tr_b16 v[44:45], v9 offset:224
    ds_read_b64_tr_b16 v[46:47], v9 offset:5344
    ds_read_b64_tr_b16 v[48:49], v9 offset:232
    ds_read_b64_tr_b16 v[50:51], v9 offset:5352
    ds_read_b64_tr_b16 v[52:53], v10 offset:288
    ds_read_b64_tr_b16 v[54:55], v10 offset:5408
    s_waitcnt lgkmcnt(10)
    buffer_store_dwordx4 v[16:19], v2, s[12:15], s40 offen offset:0 sc1
    buffer_store_dwordx4 v[20:23], v2, s[12:15], s40 offen offset:1024 sc1
    buffer_store_dwordx4 v[24:27], v2, s[12:15], s40 offen offset:2048 sc1
    buffer_store_dwordx4 v[28:31], v2, s[12:15], s40 offen offset:3072 sc1
    buffer_store_dwordx4 v[32:35], v8, s[12:15], s40 offen sc1
    s_add_u32 s40, s40, s41
    s_waitcnt lgkmcnt(0)
    buffer_store_dwordx4 v[36:39], v2, s[12:15], s40 offen offset:0 sc1
    buffer_store_dwordx4 v[40:43], v2, s[12:15], s40 offen offset:1024 sc1
    buffer_store_dwordx4 v[44:47], v2, s[12:15], s40 offen offset:2048 sc1
    buffer_store_dwordx4 v[48:51], v2, s[12:15], s40 offen offset:3072 sc1
    buffer_store_dwordx4 v[52:55], v8, s[12:15], s40 offen sc1
    s_add_u32 s40, s40, s41
    ds_read_b64_tr_b16 v[56:57], v9 offset:320
    ds_read_b64_tr_b16 v[58:59], v9 offset:5440
    ds_read_b64_tr_b16 v[60:61], v9 offset:328
    ds_read_b64_tr_b16 v[62:63], v9 offset:5448
    ds_read_b64_tr_b16 v[64:65], v9 offset:384
    ds_read_b64_tr_b16 v[66:67], v9 offset:5504
    ds_read_b64_tr_b16 v[68:69], v9 offset:392
    ds_read_b64_tr_b16 v[70:71], v9 offset:5512
    ds_read_b64_tr_b16 v[72:73], v10 offset:448
    ds_read_b64_tr_b16 v[74:75], v10 offset:5568
    ds_read_b64_tr_b16 v[76:77], v9 offset:480
    ds_read_b64_tr_b16 v[78:79], v9 offset:5600
    ds_read_b64_tr_b16 v[80:81], v9 offset:488
    ds_read_b64_tr_b16 v[82:83], v9 offset:5608
    ds_read_b64_tr_b16 v[84:85], v9 offset:544
    ds_read_b64_tr_b16 v[86:87], v9 offset:5664
    ds_read_b64_tr_b16 v[88:89], v9 offset:552
    ds_read_b64_tr_b16 v[90:91], v9 offset:5672
    ds_read_b64_tr_b16 v[92:93], v10 offset:608
    ds_read_b64_tr_b16 v[94:95], v10 offset:5728
    s_waitcnt lgkmcnt(10)
    buffer_store_dwordx4 v[56:59], v2, s[12:15], s40 offen offset:0 sc1
    buffer_store_dwordx4 v[60:63], v2, s[12:15], s40 offen offset:1024 sc1
    buffer_store_dwordx4 v[64:67], v2, s[12:15], s40 offen offset:2048 sc1
    buffer_store_dwordx4 v[68:71], v2, s[12:15], s40 offen offset:3072 sc1
    buffer_store_dwordx4 v[72:75], v8, s[12:15], s40 offen sc1
    s_add_u32 s40, s40, s41
    s_waitcnt lgkmcnt(0)
    buffer_store_dwordx4 v[76:79], v2, s[12:15], s40 offen offset:0 sc1
    buffer_store_dwordx4 v[80:83], v2, s[12:15], s40 offen offset:1024 sc1
    buffer_store_dwordx4 v[84:87], v2, s[12:15], s40 offen offset:2048 sc1
    buffer_store_dwordx4 v[88:91], v2, s[12:15], s40 offen offset:3072 sc1
    buffer_store_dwordx4 v[92:95], v8, s[12:15], s40 offen sc1
    s_add_u32 s40, s40, s41
    s_mov_b64 exec, 1
    buffer_load_dword v5, off, s[16:19], 0 sc1
    v_mov_b32 v4, 1
    s_waitcnt vmcnt(0)
    s_mov_b32 s21, 16384
L_kf_fus_ini_23:
    v_cmp_ne_u32 vcc, 16, v5
    s_sub_u32 s21, s21, 1
    s_cbranch_vccz L_kf_fus_inid_24
    s_cbranch_scc1 L_kf_fus_inid_24
    s_sleep 8
    buffer_load_dword v5, off, s[16:19], 0 sc1
    s_waitcnt vmcnt(0)
    s_branch L_kf_fus_ini_23
L_kf_fus_inid_24:
    buffer_atomic_add v4, off, s[16:19], 0 offset:128 sc0 sc1
    s_waitcnt vmcnt(0)
    v_readfirstlane_b32 s21, v4
    s_mov_b64 exec, -1
    s_cmp_eq_u32 s21, 327
    s_cbranch_scc0 L_kf_fus_bc_25
    v_mov_b32 v4, 1
    v_lshlrev_b32 v5, 7, v1
    s_mov_b32 s21, 26345472
    buffer_store_dword v4, v5, s[12:15], s21 offen offset:12 sc1
    s_mov_b32 s21, 26353664
    buffer_store_dword v4, v5, s[12:15], s21 offen offset:12 sc1
    s_mov_b32 s21, 26361856
    buffer_store_dword v4, v5, s[12:15], s21 offen offset:12 sc1
    s_mov_b32 s21, 26370048
    buffer_store_dword v4, v5, s[12:15], s21 offen offset:12 sc1
L_kf_fus_bc_25:
    s_branch L_f_idle1
L_f_w9:
    s_cmp_lt_u32 s2, 192
    s_cbranch_scc1 L_f_h0
    s_cmp_ge_u32 s30, 15
    s_cbranch_scc1 L_f_h0
    s_cmp_ge_u32 s2, 240
    s_cbranch_scc1 L_f_h0
    s_sub_u32 s31, s2, 96
    s_cmp_ge_u32 s2, 232
    s_cselect_b32 s21, 4, 0
    s_sub_u32 s31, s31, s21
    s_barrier
    s_load_dwordx2 s[32:33], s[0:1], 48
    s_load_dwordx2 s[34:35], s[0:1], 16
    s_and_b32 s44, s31, 1
    s_lshr_b32 s31, s31, 1
    v_add_u32 v8, 4096, v2
    s_mov_b32 s43, 118784
    s_waitcnt lgkmcnt(0)
    s_cmp_ge_u32 s31, 48
    s_cbranch_scc1 L_kf_fus_wo_26
    s_mul_i32 s36, s31, 40960
    s_mov_b32 s37, 20480
    s_mov_b32 s38, 10240
    s_mov_b32 s39, 0
    s_mul_i32 s40, s31, 5120
    s_add_u32 s40, s40, 15237120
    s_mov_b32 s41, 245760
    s_mov_b32 s42, 1966080
    s_branch L_kf_fus_dwgo_27
L_kf_fus_wo_26:
    s_mov_b64 s[32:33], s[34:35]
    s_sub_u32 s31, s31, 48
    s_mul_i32 s40, s31, 5120
    s_add_u32 s40, s40, 10485760
    s_mov_b32 s41, 102400
    s_mov_b32 s42, 819200
    s_mul_i32 s36, s31, 51200
    s_mov_b32 s37, 25600
    s_mov_b32 s38, 10240
    s_mov_b32 s39, 0
    s_cmp_lt_u32 s31, 16
    s_cbranch_scc1 L_kf_fus_dwgo_27
    s_mul_i32 s36, s31, 204800
    s_sub_u32 s36, s36, 3256320
    s_mov_b32 s37, 102400
    s_mov_b32 s38, 25600
    s_mov_b32 s39, 46080
L_kf_fus_dwgo_27:
    s_mul_i32 s21, s44, 640
    s_add_u32 s36, s36, s21
    s_mul_i32 s21, s44, s41
    s_lshl2_add_u32 s40, s21, s40
    s_mov_b32 s48, s32
    s_mov_b32 s49, s33
    s_mov_b32 s50, 0x0
    s_mov_b32 s51, 0x20000
    s_mov_b32 s50, s42
    s_barrier
    v_add_u32 v4, 0, v1
    v_mul_u32_u24 v4, 1639, v4
    v_lshrrev_b32 v4, 16, v4
    v_mul_u32_u24 v5, 640, v4
    v_add_u32 v5, v5, v2
    v_lshrrev_b32 v4, 2, v4
    v_mad_u32_u24 v11, v4, s39, v5
    v_add_u32 v4, 64, v1
    v_mul_u32_u24 v4, 1639, v4
    v_lshrrev_b32 v4, 16, v4
    v_mul_u32_u24 v5, 640, v4
    v_add_u32 v5, v5, v2
    v_lshrrev_b32 v4, 2, v4
    v_mad_u32_u24 v12, v4, s39, v5
    v_add_u32 v4, 128, v1
    v_mul_u32_u24 v4, 1639, v4
    v_lshrrev_b32 v4, 16, v4
    v_mul_u32_u24 v5, 640, v4
    v_add_u32 v5, v5, v2
    v_lshrrev_b32 v4, 2, v4
    v_mad_u32_u24 v13, v4, s39, v5
    v_add_u32 v4, 192, v1
    v_mul_u32_u24 v4, 1639, v4
    v_lshrrev_b32 v4, 16, v4
    v_mul_u32_u24 v5, 640, v4
    v_add_u32 v5, v5, v2
    v_lshrrev_b32 v4, 2, v4
    v_mad_u32_u24 v14, v4, s39, v5
    v_add_u32 v4, 256, v1
    v_mul_u32_u24 v4, 1639, v4
    v_lshrrev_b32 v4, 16, v4
    v_mul_u32_u24 v5, 640, v4
    v_add_u32 v5, v5, v8
    v_lshrrev_b32 v4, 2, v4
    v_mad_u32_u24 v15, v4, s39, v5
    s_barrier
    s_barrier
    s_barrier
    s_barrier
    s_barrier
    s_barrier
    s_mov_b32 s21, s36
    s_add_u32 m0, s43, 0
    s_nop 0
    buffer_load_dwordx4 v11, s[48:51], s21 offen offset:0  lds
    buffer_load_dwordx4 v12, s[48:51], s21 offen offset:1024  lds
    buffer_load_dwordx4 v13, s[48:51], s21 offen offset:2048  lds
    buffer_load_dwordx4 v14, s[48:51], s21 offen offset:3072  lds
    s_add_u32 m0, s43, 4096
    s_nop 0
    buffer_load_dwordx4 v15, s[48:51], s21 offen  lds
    s_mov_b32 s21, s36
    s_add_u32 s21, s21, s38
    s_add_u32 m0, s43, 5120
    s_nop 0
    buffer_load_dwordx4 v11, s[48:51], s21 offen offset:0  lds
    buffer_load_dwordx4 v12, s[48:51], s21 offen offset:1024  lds
    buffer_load_dwordx4 v13, s[48:51], s21 offen offset:2048  lds
    buffer_load_dwordx4 v14, s[48:51], s21 offen offset:3072  lds
    s_add_u32 m0, s43, 9216
    s_nop 0
    buffer_load_dwordx4 v15, s[48:51], s21 offen  lds
    s_mov_b32 s21, s36
    s_add_u32 s21, s21, s37
    s_add_u32 m0, s43, 10240
    s_nop 0
    buffer_load_dwordx4 v11, s[48:51], s21 offen offset:0  lds
    buffer_load_dwordx4 v12, s[48:51], s21 offen offset:1024  lds
    buffer_load_dwordx4 v13, s[48:51], s21 offen offset:2048  lds
    buffer_load_dwordx4 v14, s[48:51], s21 offen offset:3072  lds
    s_add_u32 m0, s43, 14336
    s_nop 0
    buffer_load_dwordx4 v15, s[48:51], s21 offen  lds
    s_mov_b32 s21, s36
    s_add_u32 s21, s21, s37
    s_add_u32 s21, s21, s38
    s_add_u32 m0, s43, 15360
    s_nop 0
    buffer_load_dwordx4 v11, s[48:51], s21 offen offset:0  lds
    buffer_load_dwordx4 v12, s[48:51], s21 offen offset:1024  lds
    buffer_load_dwordx4 v13, s[48:51], s21 offen offset:2048  lds
    buffer_load_dwordx4 v14, s[48:51], s21 offen offset:3072  lds
    s_add_u32 m0, s43, 19456
    s_nop 0
    buffer_load_dwordx4 v15, s[48:51], s21 offen  lds
    v_lshrrev_b32 v4, 5, v1
    v_lshlrev_b32 v4, 4, v4
    v_bfe_u32 v5, v1, 2, 3
    v_add_u32 v4, v4, v5
    v_mul_u32_u24 v4, 640, v4
    v_and_b32 v5, 3, v1
    v_add_u32 v4, s43, v4
    v_lshl_add_u32 v9, v5, 4, v4
    v_lshl_add_u32 v10, v5, 3, v4
    s_barrier
    s_barrier
    s_barrier
    s_waitcnt vmcnt(0)
    ds_read_b64_tr_b16 v[16:17], v9 offset:0
    ds_read_b64_tr_b16 v[18:19], v9 offset:5120
    ds_read_b64_tr_b16 v[20:21], v9 offset:8
    ds_read_b64_tr_b16 v[22:23], v9 offset:5128
    ds_read_b64_tr_b16 v[24:25], v9 offset:64
    ds_read_b64_tr_b16 v[26:27], v9 offset:5184
    ds_read_b64_tr_b16 v[28:29], v9 offset:72
    ds_read_b64_tr_b16 v[30:31], v9 offset:5192
    ds_read_b64_tr_b16 v[32:33], v10 offset:128
    ds_read_b64_tr_b16 v[34:35], v10 offset:5248
    ds_read_b64_tr_b16 v[36:37], v9 offset:160
    ds_read_b64_tr_b16 v[38:39], v9 offset:5280
    ds_read_b64_tr_b16 v[40:41], v9 offset:168
    ds_read_b64_tr_b16 v[42:43], v9 offset:5288
    ds_read_b64_tr_b16 v[44:45], v9 offset:224
    ds_read_b64_tr_b16 v[46:47], v9 offset:5344
    ds_read_b64_tr_b16 v[48:49], v9 offset:232
    ds_read_b64_tr_b16 v[50:51], v9 offset:5352
    ds_read_b64_tr_b16 v[52:53], v10 offset:288
    ds_read_b64_tr_b16 v[54:55], v10 offset:5408
    s_waitcnt lgkmcnt(10)
    buffer_store_dwordx4 v[16:19], v2, s[12:15], s40 offen offset:0 sc1
    buffer_store_dwordx4 v[20:23], v2, s[12:15], s40 offen offset:1024 sc1
    buffer_store_dwordx4 v[24:27], v2, s[12:15], s40 offen offset:2048 sc1
    buffer_store_dwordx4 v[28:31], v2, s[12:15], s40 offen offset:3072 sc1
    buffer_store_dwordx4 v[32:35], v8, s[12:15], s40 offen sc1
    s_add_u32 s40, s40, s41
    s_waitcnt lgkmcnt(0)
    buffer_store_dwordx4 v[36:39], v2, s[12:15], s40 offen offset:0 sc1
    buffer_store_dwordx4 v[40:43], v2, s[12:15], s40 offen offset:1024 sc1
    buffer_store_dwordx4 v[44:47], v2, s[12:15], s40 offen offset:2048 sc1
    buffer_store_dwordx4 v[48:51], v2, s[12:15], s40 offen offset:3072 sc1
    buffer_store_dwordx4 v[52:55], v8, s[12:15], s40 offen sc1
    s_add_u32 s40, s40, s41
    ds_read_b64_tr_b16 v[56:57], v9 offset:320
    ds_read_b64_tr_b16 v[58:59], v9 offset:5440
    ds_read_b64_tr_b16 v[60:61], v9 offset:328
    ds_read_b64_tr_b16 v[62:63], v9 offset:5448
    ds_read_b64_tr_b16 v[64:65], v9 offset:384
    ds_read_b64_tr_b16 v[66:67], v9 offset:5504
    ds_read_b64_tr_b16 v[68:69], v9 offset:392
    ds_read_b64_tr_b16 v[70:71], v9 offset:5512
    ds_read_b64_tr_b16 v[72:73], v10 offset:448
    ds_read_b64_tr_b16 v[74:75], v10 offset:5568
    ds_read_b64_tr_b16 v[76:77], v9 offset:480
    ds_read_b64_tr_b16 v[78:79], v9 offset:5600
    ds_read_b64_tr_b16 v[80:81], v9 offset:488
    ds_read_b64_tr_b16 v[82:83], v9 offset:5608
    ds_read_b64_tr_b16 v[84:85], v9 offset:544
    ds_read_b64_tr_b16 v[86:87], v9 offset:5664
    ds_read_b64_tr_b16 v[88:89], v9 offset:552
    ds_read_b64_tr_b16 v[90:91], v9 offset:5672
    ds_read_b64_tr_b16 v[92:93], v10 offset:608
    ds_read_b64_tr_b16 v[94:95], v10 offset:5728
    s_waitcnt lgkmcnt(10)
    buffer_store_dwordx4 v[56:59], v2, s[12:15], s40 offen offset:0 sc1
    buffer_store_dwordx4 v[60:63], v2, s[12:15], s40 offen offset:1024 sc1
    buffer_store_dwordx4 v[64:67], v2, s[12:15], s40 offen offset:2048 sc1
    buffer_store_dwordx4 v[68:71], v2, s[12:15], s40 offen offset:3072 sc1
    buffer_store_dwordx4 v[72:75], v8, s[12:15], s40 offen sc1
    s_add_u32 s40, s40, s41
    s_waitcnt lgkmcnt(0)
    buffer_store_dwordx4 v[76:79], v2, s[12:15], s40 offen offset:0 sc1
    buffer_store_dwordx4 v[80:83], v2, s[12:15], s40 offen offset:1024 sc1
    buffer_store_dwordx4 v[84:87], v2, s[12:15], s40 offen offset:2048 sc1
    buffer_store_dwordx4 v[88:91], v2, s[12:15], s40 offen offset:3072 sc1
    buffer_store_dwordx4 v[92:95], v8, s[12:15], s40 offen sc1
    s_add_u32 s40, s40, s41
L_f_hsig:
    s_mov_b64 exec, 1
    buffer_load_dword v5, off, s[16:19], 0 sc1
    v_mov_b32 v4, 1
    s_waitcnt vmcnt(0)
    s_mov_b32 s21, 16384
L_kf_fus_ini_28:
    v_cmp_ne_u32 vcc, 16, v5
    s_sub_u32 s21, s21, 1
    s_cbranch_vccz L_kf_fus_inid_29
    s_cbranch_scc1 L_kf_fus_inid_29
    s_sleep 8
    buffer_load_dword v5, off, s[16:19], 0 sc1
    s_waitcnt vmcnt(0)
    s_branch L_kf_fus_ini_28
L_kf_fus_inid_29:
    buffer_atomic_add v4, off, s[16:19], 0 offset:128 sc0 sc1
    s_waitcnt vmcnt(0)
    v_readfirstlane_b32 s21, v4
    s_mov_b64 exec, -1
    s_cmp_eq_u32 s21, 327
    s_cbranch_scc0 L_kf_fus_bc_30
    v_mov_b32 v4, 1
    v_lshlrev_b32 v5, 7, v1
    s_mov_b32 s21, 26345472
    buffer_store_dword v4, v5, s[12:15], s21 offen offset:12 sc1
    s_mov_b32 s21, 26353664
    buffer_store_dword v4, v5, s[12:15], s21 offen offset:12 sc1
    s_mov_b32 s21, 26361856
    buffer_store_dword v4, v5, s[12:15], s21 offen offset:12 sc1
    s_mov_b32 s21, 26370048
    buffer_store_dword v4, v5, s[12:15], s21 offen offset:12 sc1
L_kf_fus_bc_30:
    s_branch L_f_h1
L_f_h0:
    s_barrier
    s_barrier
    s_barrier
    s_barrier
    s_barrier
    s_barrier
    s_barrier
    s_barrier
    s_barrier
    s_barrier
    s_barrier
L_f_h1:
    s_mov_b32 s32, 16384
    s_mov_b64 exec, 1
L_f_hp:
    buffer_load_dword v4, off, s[12:15], s24 offset:12 sc1
    s_sub_u32 s32, s32, 1
    s_waitcnt vmcnt(0)
    v_cmp_ne_u32 vcc, 1, v4
    s_cmp_eq_u32 s32, 0
    s_cbranch_scc1 L_f_hgo
    s_cbranch_vccz L_f_hgo
    s_sleep 16
    s_branch L_f_hp
L_f_hgo:
    s_mov_b64 exec, -1
    s_mul_i32 s31, s26, 102400
    s_add_u32 s31, s31, 10485760
    s_mov_b32 m0, 59136
    s_mov_b32 s32, 16
    s_cmp_eq_u32 s20, 8
    s_cbranch_scc1 L_f_hc2
    s_add_u32 s31, s31, 65536
    s_mov_b32 m0, 124672
    s_mov_b32 s32, 9
L_f_hc1:
    buffer_load_dwordx4 v2, s[12:15], s31 offen offset:0 sc1 lds
    buffer_load_dwordx4 v2, s[12:15], s31 offen offset:1024 sc1 lds
    buffer_load_dwordx4 v2, s[12:15], s31 offen offset:2048 sc1 lds
    buffer_load_dwordx4 v2, s[12:15], s31 offen offset:3072 sc1 lds
    s_add_u32 m0, m0, 4096
    s_add_u32 s31, s31, 4096
    s_sub_u32 s32, s32, 1
    s_cmp_lg_u32 s32, 0
    s_waitcnt vmcnt(8)
    s_cbranch_scc1 L_f_hc1
    s_mul_i32 s31, s28, 245760
    s_add_u32 s31, s31, 11304960
    s_mov_b32 m0, 0
    s_mov_b32 s32, 6
L_f_hc2:
    buffer_load_dwordx4 v2, s[12:15], s31 offen offset:0 sc1 lds
    buffer_load_dwordx4 v2, s[12:15], s31 offen offset:1024 sc1 lds
    buffer_load_dwordx4 v2, s[12:15], s31 offen offset:2048 sc1 lds
    buffer_load_dwordx4 v2, s[12:15], s31 offen offset:3072 sc1 lds
    s_add_u32 m0, m0, 4096
    s_add_u32 s31, s31, 4096
    s_sub_u32 s32, s32, 1
    s_cmp_lg_u32 s32, 0
    s_waitcnt vmcnt(8)
    s_cbranch_scc1 L_f_hc2
L_f_hend:
    s_sub_u32 s32, s20, 8
    s_mul_i32 s32, s32, 6144
    s_mul_i32 s31, s28, 245760
    s_add_u32 s31, s31, s32
    s_add_u32 s31, s31, 11329536
    v_add_u32 v152, s32, v2
    v_add_u32 v153, 49152, v152
    v_and_b32 v5, 28, v1
    v_add_u32 v5, 163648, v5
    buffer_load_dwordx4 v[8:11], v2, s[12:15], s31 offen offset:0 sc1
    buffer_load_dwordx4 v[12:15], v2, s[12:15], s31 offen offset:1024 sc1
    buffer_load_dwordx4 v[16:19], v2, s[12:15], s31 offen offset:2048 sc1
    s_add_u32 s31, s31, 3072
    s_waitcnt vmcnt(8)
    buffer_load_dwordx4 v[20:23], v2, s[12:15], s31 offen offset:0 sc1
    buffer_load_dwordx4 v[24:27], v2, s[12:15], s31 offen offset:1024 sc1
    buffer_load_dwordx4 v[28:31], v2, s[12:15], s31 offen offset:2048 sc1
    s_add_u32 s31, s31, 9216
    s_waitcnt vmcnt(8)
    buffer_load_dwordx4 v[32:35], v2, s[12:15], s31 offen offset:0 sc1
    buffer_load_dwordx4 v[36:39], v2, s[12:15], s31 offen offset:1024 sc1
    buffer_load_dwordx4 v[40:43], v2, s[12:15], s31 offen offset:2048 sc1
    s_add_u32 s31, s31, 3072
    s_waitcnt vmcnt(8)
    buffer_load_dwordx4 v[44:47], v2, s[12:15], s31 offen offset:0 sc1
    buffer_load_dwordx4 v[48:51], v2, s[12:15], s31 offen offset:1024 sc1
    buffer_load_dwordx4 v[52:55], v2, s[12:15], s31 offen offset:2048 sc1
    s_add_u32 s31, s31, 9216
    s_waitcnt vmcnt(8)
    buffer_load_dwordx4 v[56:59], v2, s[12:15], s31 offen offset:0 sc1
    buffer_load_dwordx4 v[60:63], v2, s[12:15], s31 offen offset:1024 sc1
    buffer_load_dwordx4 v[64:67], v2, s[12:15], s31 offen offset:2048 sc1
    s_add_u32 s31, s31, 3072
    s_waitcnt vmcnt(8)
    buffer_load_dwordx4 v[68:71], v2, s[12:15], s31 offen offset:0 sc1
    buffer_load_dwordx4 v[72:75], v2, s[12:15], s31 offen offset:1024 sc1
    buffer_load_dwordx4 v[76:79], v2, s[12:15], s31 offen offset:2048 sc1
    s_add_u32 s31, s31, 9216
    s_waitcnt vmcnt(8)
    buffer_load_dwordx4 v[80:83], v2, s[12:15], s31 offen offset:0 sc1
    buffer_load_dwordx4 v[84:87], v2, s[12:15], s31 offen offset:1024 sc1
    buffer_load_dwordx4 v[88:91], v2, s[12:15], s31 offen offset:2048 sc1
    s_add_u32 s31, s31, 3072
    s_waitcnt vmcnt(8)
    buffer_load_dwordx4 v[92:95], v2, s[12:15], s31 offen offset:0 sc1
    buffer_load_dwordx4 v[96:99], v2, s[12:15], s31 offen offset:1024 sc1
    buffer_load_dwordx4 v[100:103], v2, s[12:15], s31 offen offset:2048 sc1
    s_add_u32 s31, s31, 9216
    s_waitcnt vmcnt(8)
    buffer_load_dwordx4 v[104:107], v2, s[12:15], s31 offen offset:0 sc1
    buffer_load_dwordx4 v[108:111], v2, s[12:15], s31 offen offset:1024 sc1
    buffer_load_dwordx4 v[112:115], v2, s[12:15], s31 offen offset:2048 sc1
    s_add_u32 s31, s31, 3072
    s_waitcnt vmcnt(8)
    buffer_load_dwordx4 v[116:119], v2, s[12:15], s31 offen offset:0 sc1
    buffer_load_dwordx4 v[120:123], v2, s[12:15], s31 offen offset:1024 sc1
    buffer_load_dwordx4 v[124:127], v2, s[12:15], s31 offen offset:2048 sc1
    s_add_u32 s31, s31, 9216
    s_waitcnt vmcnt(8)
    buffer_load_dwordx4 v[128:131], v2, s[12:15], s31 offen offset:0 sc1
    buffer_load_dwordx4 v[132:135], v2, s[12:15], s31 offen offset:1024 sc1
    buffer_load_dwordx4 v[136:139], v2, s[12:15], s31 offen offset:2048 sc1
    s_add_u32 s31, s31, 3072
    s_waitcnt vmcnt(8)
    buffer_load_dwordx4 v[140:143], v2, s[12:15], s31 offen offset:0 sc1
    buffer_load_dwordx4 v[144:147], v2, s[12:15], s31 offen offset:1024 sc1
    buffer_load_dwordx4 v[148:151], v2, s[12:15], s31 offen offset:2048 sc1
    s_add_u32 s31, s31, 9216
    s_waitcnt vmcnt(8)
    s_barrier
    ds_read_b32 v4, v5
    s_waitcnt lgkmcnt(0)
    v_cmp_ne_u32 vcc, 0, v4
    s_cbranch_vccz L_f_hnf
    s_barrier
    s_barrier
L_f_hnf:
    s_barrier
    s_waitcnt vmcnt(0)
    s_barrier
    s_barrier
    ds_write_b128 v153, v[56:59] offset:0
    ds_write_b128 v153, v[60:63] offset:1024
    ds_write_b128 v153, v[64:67] offset:2048
    ds_write_b128 v153, v[68:71] offset:3072
    ds_write_b128 v153, v[72:75] offset:4096
    ds_write_b128 v153, v[76:79] offset:5120
    ds_write_b128 v153, v[80:83] offset:12288
    ds_write_b128 v153, v[84:87] offset:13312
    ds_write_b128 v153, v[88:91] offset:14336
    ds_write_b128 v153, v[92:95] offset:15360
    ds_write_b128 v153, v[96:99] offset:16384
    ds_write_b128 v153, v[100:103] offset:17408
    ds_write_b128 v153, v[104:107] offset:24576
    ds_write_b128 v153, v[108:111] offset:25600
    ds_write_b128 v153, v[112:115] offset:26624
    ds_write_b128 v153, v[116:119] offset:27648
    ds_write_b128 v153, v[120:123] offset:28672
    ds_write_b128 v153, v[124:127] offset:29696
    ds_write_b128 v153, v[128:131] offset:36864
    ds_write_b128 v153, v[132:135] offset:37888
    ds_write_b128 v153, v[136:139] offset:38912
    ds_write_b128 v153, v[140:143] offset:39936
    ds_write_b128 v153, v[144:147] offset:40960
    ds_write_b128 v153, v[148:151] offset:41984
    ds_write_b128 v152, v[8:11] offset:24576
    ds_write_b128 v152, v[12:15] offset:25600
    ds_write_b128 v152, v[16:19] offset:26624
    ds_write_b128 v152, v[20:23] offset:27648
    ds_write_b128 v152, v[24:27] offset:28672
    ds_write_b128 v152, v[28:31] offset:29696
    ds_write_b128 v152, v[32:35] offset:36864
    ds_write_b128 v152, v[36:39] offset:37888
    ds_write_b128 v152, v[40:43] offset:38912
    ds_write_b128 v152, v[44:47] offset:39936
    ds_write_b128 v152, v[48:51] offset:40960
    ds_write_b128 v152, v[52:55] offset:41984
    s_waitcnt lgkmcnt(0)
    s_waitcnt vmcnt(0)
    s_endpgm
L_kf_fus_end_1:
    s_endpgm
L_k2_fb:
    s_waitcnt vmcnt(0) lgkmcnt(0)
    s_barrier
    s_mov_b32 s38, 1
    s_mov_b32 s34, s39
    s_mov_b32 s37, 64
    v_mov_b32 v159, 0xff800000
    v_mov_b32 v160, 0xff800000
L_k2_fbl:
    buffer_load_dwordx2 v[150:151], v155, s[12:15], s34 offen
    buffer_load_dwordx4 v[108:111], v154, s[12:15], s34 offen
    s_add_u32 s34, s34, 512
    s_min_u32 s34, s34, s40
    s_waitcnt vmcnt(0)
    v_mfma_f32_32x32x4_2b_bf16 v[4:35], v[150:151], v[148:149], 0
    s_nop 15
    s_nop 3
    v_mfma_f32_32x32x16_bf16 v[4:19], v[108:111], v[100:103], v[4:19]
    v_mfma_f32_32x32x16_bf16 v[20:35], v[108:111], v[104:107], v[20:35]
    s_sub_u32 s37, s37, 1
    s_cmp_lg_u32 s37, 0
    s_nop 7
    s_nop 3
    v_max3_f32 v159, v159, v4, v5
    v_max3_f32 v159, v159, v6, v7
    v_max3_f32 v159, v159, v8, v9
    v_max3_f32 v159, v159, v10, v11
    v_max3_f32 v159, v159, v12, v13
    v_max3_f32 v159, v159, v14, v15
    v_max3_f32 v159, v159, v16, v17
    v_max3_f32 v159, v159, v18, v19
    v_max3_f32 v160, v160, v20, v21
    v_max3_f32 v160, v160, v22, v23
    v_max3_f32 v160, v160, v24, v25
    v_max3_f32 v160, v160, v26, v27
    v_max3_f32 v160, v160, v28, v29
    v_max3_f32 v160, v160, v30, v31
    v_max3_f32 v160, v160, v32, v33
    v_max3_f32 v160, v160, v34, v35
    s_cbranch_scc1 L_k2_fbl
    v_mov_b32 v161, v159
    v_mov_b32 v162, v160
    s_nop 1
    v_permlane32_swap_b32 v159, v161
    v_permlane32_swap_b32 v160, v162
    s_nop 1
    v_max_f32 v159, v159, v161
    v_max_f32 v160, v160, v162
    s_lshl_b32 s21, s33, 14
    s_add_u32 s34, s39, s21
    s_mul_i32 s21, s33, 1310720
    s_add_u32 s36, s41, s21
    buffer_load_dwordx2 v[150:151], v155, s[12:15], s34 offen
    buffer_load_dwordx4 v[108:111], v154, s[12:15], s34 offen
    s_add_u32 s34, s34, 512
    s_min_u32 s34, s34, s40
    v_mov_b32 v68, 0
    v_mov_b32 v69, 0
    v_mov_b32 v70, 0
    v_mov_b32 v71, 0
    v_mov_b32 v72, 0
    v_mov_b32 v73, 0
    v_mov_b32 v74, 0
    v_mov_b32 v75, 0
    v_mov_b32 v76, 0
    v_mov_b32 v77, 0
    v_mov_b32 v78, 0
    v_mov_b32 v79, 0
    v_mov_b32 v80, 0
    v_mov_b32 v81, 0
    v_mov_b32 v82, 0
    v_mov_b32 v83, 0
    v_mov_b32 v84, 0
    v_mov_b32 v85, 0
    v_mov_b32 v86, 0
    v_mov_b32 v87, 0
    v_mov_b32 v88, 0
    v_mov_b32 v89, 0
    v_mov_b32 v90, 0
    v_mov_b32 v91, 0
    v_mov_b32 v92, 0
    v_mov_b32 v93, 0
    v_mov_b32 v94, 0
    v_mov_b32 v95, 0
    v_mov_b32 v96, 0
    v_mov_b32 v97, 0
    v_mov_b32 v98, 0
    v_mov_b32 v99, 0
    buffer_load_dwordx2 v[152:153], v155, s[12:15], s34 offen
    buffer_load_dwordx4 v[112:115], v154, s[12:15], s34 offen
    s_add_u32 s34, s34, 512
    s_min_u32 s34, s34, s40
    s_mov_b64 exec, s[42:43]
    buffer_load_dwordx4 v[116:119], v156, s[12:15], s36 offen
    buffer_load_dwordx4 v[120:123], v157, s[12:15], s36 offen
    s_mov_b64 exec, -1
    s_add_u32 s36, s36, 40960
    s_min_u32 s36, s36, s35
    s_waitcnt vmcnt(5)
    v_mfma_f32_32x32x4_2b_bf16 v[4:35], v[150:151], v[148:149], 0
    s_nop 15
    s_waitcnt vmcnt(4)
    s_nop 3
    v_mfma_f32_32x32x16_bf16 v[4:19], v[108:111], v[100:103], v[4:19]
    v_mfma_f32_32x32x16_bf16 v[20:35], v[108:111], v[104:107], v[20:35]
    v_mov_b32 v60, 0
    v_mov_b32 v61, 0
    v_mov_b32 v62, 0
    v_mov_b32 v63, 0
    v_mov_b32 v64, 0
    v_mov_b32 v65, 0
    v_mov_b32 v66, 0
    v_mov_b32 v67, 0
    s_mov_b64 exec, s[42:43]
    buffer_load_dwordx4 v[124:127], v156, s[12:15], s36 offen
    buffer_load_dwordx4 v[128:131], v157, s[12:15], s36 offen
    s_mov_b64 exec, -1
    s_add_u32 s36, s36, 40960
    s_min_u32 s36, s36, s35
    s_mov_b64 exec, s[42:43]
    buffer_load_dwordx4 v[132:135], v156, s[12:15], s36 offen
    buffer_load_dwordx4 v[136:139], v157, s[12:15], s36 offen
    s_mov_b64 exec, -1
    s_add_u32 s36, s36, 40960
    s_min_u32 s36, s36, s35
    buffer_load_dwordx2 v[150:151], v155, s[12:15], s34 offen
    buffer_load_dwordx4 v[108:111], v154, s[12:15], s34 offen
    s_add_u32 s34, s34, 512
    s_min_u32 s34, s34, s40
    s_mov_b32 s37, 16
    s_nop 1
    s_mov_b32 s47, 0
    .p2align 6
L_k2_loop2:
    v_sub_f32 v4, v4, v159
    v_sub_f32 v5, v5, v159
    v_exp_f32 v4, v4
    v_exp_f32 v5, v5
    v_smfmac_f32_32x32x32_bf16 v[84:99], v[144:147], v[60:67], v158
    s_mov_b64 exec, s[42:43]
    buffer_load_dwordx4 v[140:143], v156, s[12:15], s36 offen
    buffer_load_dwordx4 v[144:147], v157, s[12:15], s36 offen
    s_mov_b64 exec, -1
    s_add_u32 s36, s36, 40960
    s_min_u32 s36, s36, s35
    v_sub_f32 v6, v6, v159
    v_sub_f32 v7, v7, v159
    v_exp_f32 v6, v6
    v_exp_f32 v7, v7
    v_sub_f32 v8, v8, v159
    v_sub_f32 v9, v9, v159
    v_exp_f32 v8, v8
    v_exp_f32 v9, v9
    s_waitcnt vmcnt(7)
    v_mfma_f32_32x32x4_2b_bf16 v[36:67], v[152:153], v[148:149], 0
    v_sub_f32 v10, v10, v159
    v_sub_f32 v11, v11, v159
    v_exp_f32 v10, v10
    v_exp_f32 v11, v11
    v_sub_f32 v12, v12, v159
    v_sub_f32 v13, v13, v159
    v_exp_f32 v12, v12
    buffer_load_dwordx2 v[152:153], v155, s[12:15], s34 offen
    v_exp_f32 v13, v13
    v_sub_f32 v14, v14, v159
    v_sub_f32 v15, v15, v159
    v_exp_f32 v14, v14
    v_exp_f32 v15, v15
    v_sub_f32 v16, v16, v159
    v_sub_f32 v17, v17, v159
    v_exp_f32 v16, v16
    v_exp_f32 v17, v17
    v_smfmac_f32_32x32x32_bf16 v[68:83], v[116:119], v[4:11], v158
    v_sub_f32 v18, v18, v159
    v_sub_f32 v19, v19, v159
    v_exp_f32 v18, v18
    v_exp_f32 v19, v19
    v_sub_f32 v20, v20, v160
    v_sub_f32 v21, v21, v160
    v_exp_f32 v20, v20
    v_exp_f32 v21, v21
    v_smfmac_f32_32x32x32_bf16 v[68:83], v[120:123], v[12:19], v158
    v_sub_f32 v22, v22, v160
    v_sub_f32 v23, v23, v160
    v_exp_f32 v22, v22
    v_exp_f32 v23, v23
    v_sub_f32 v24, v24, v160
    v_sub_f32 v25, v25, v160
    v_exp_f32 v24, v24
    v_exp_f32 v25, v25
    s_waitcnt vmcnt(7)
    v_mfma_f32_32x32x16_bf16 v[36:51], v[112:115], v[100:103], v[36:51]
    v_sub_f32 v26, v26, v160
    v_sub_f32 v27, v27, v160
    v_exp_f32 v26, v26
    v_exp_f32 v27, v27
    v_sub_f32 v28, v28, v160
    v_sub_f32 v29, v29, v160
    v_exp_f32 v28, v28
    v_exp_f32 v29, v29
    v_mfma_f32_32x32x16_bf16 v[52:67], v[112:115], v[104:107], v[52:67]
    buffer_load_dwordx4 v[112:115], v154, s[12:15], s34 offen
    s_add_u32 s34, s34, 512
    s_min_u32 s34, s34, s40
    v_sub_f32 v30, v30, v160
    v_sub_f32 v31, v31, v160
    v_exp_f32 v30, v30
    v_exp_f32 v31, v31
    v_sub_f32 v32, v32, v160
    v_sub_f32 v33, v33, v160
    v_exp_f32 v32, v32
    v_exp_f32 v33, v33
    v_smfmac_f32_32x32x32_bf16 v[84:99], v[116:119], v[20:27], v158
    v_sub_f32 v34, v34, v160
    v_sub_f32 v35, v35, v160
    v_exp_f32 v34, v34
    v_exp_f32 v35, v35
    v_sub_f32 v36, v36, v159
    v_sub_f32 v37, v37, v159
    v_exp_f32 v36, v36
    v_exp_f32 v37, v37
    v_smfmac_f32_32x32x32_bf16 v[84:99], v[120:123], v[28:35], v158
    s_mov_b64 exec, s[42:43]
    buffer_load_dwordx4 v[116:119], v156, s[12:15], s36 offen
    buffer_load_dwordx4 v[120:123], v157, s[12:15], s36 offen
    s_mov_b64 exec, -1
    s_add_u32 s36, s36, 40960
    s_min_u32 s36, s36, s35
    v_sub_f32 v38, v38, v159
    v_sub_f32 v39, v39, v159
    v_exp_f32 v38, v38
    v_exp_f32 v39, v39
    v_sub_f32 v40, v40, v159
    v_sub_f32 v41, v41, v159
    v_exp_f32 v40, v40
    v_exp_f32 v41, v41
    s_waitcnt vmcnt(7)
    v_mfma_f32_32x32x4_2b_bf16 v[4:35], v[150:151], v[148:149], 0
    v_sub_f32 v42, v42, v159
    v_sub_f32 v43, v43, v159
    v_exp_f32 v42, v42
    v_exp_f32 v43, v43
    v_sub_f32 v44, v44, v159
    v_sub_f32 v45, v45, v159
    v_exp_f32 v44, v44
    buffer_load_dwordx2 v[150:151], v155, s[12:15], s34 offen
    v_exp_f32 v45, v45
    v_sub_f32 v46, v46, v159
    v_sub_f32 v47, v47, v159
    v_exp_f32 v46, v46
    v_exp_f32 v47, v47
    v_sub_f32 v48, v48, v159
    v_sub_f32 v49, v49, v159
    v_exp_f32 v48, v48
    v_exp_f32 v49, v49
    v_smfmac_f32_32x32x32_bf16 v[68:83], v[124:127], v[36:43], v158
    v_sub_f32 v50, v50, v159
    v_sub_f32 v51, v51, v159
    v_exp_f32 v50, v50
    v_exp_f32 v51, v51
    v_sub_f32 v52, v52, v160
    v_sub_f32 v53, v53, v160
    v_exp_f32 v52, v52
    v_exp_f32 v53, v53
    v_smfmac_f32_32x32x32_bf16 v[68:83], v[128:131], v[44:51], v158
    v_sub_f32 v54, v54, v160
    v_sub_f32 v55, v55, v160
    v_exp_f32 v54, v54
    v_exp_f32 v55, v55
    v_sub_f32 v56, v56, v160
    v_sub_f32 v57, v57, v160
    v_exp_f32 v56, v56
    v_exp_f32 v57, v57
    s_waitcnt vmcnt(7)
    v_mfma_f32_32x32x16_bf16 v[4:19], v[108:111], v[100:103], v[4:19]
    v_sub_f32 v58, v58, v160
    v_sub_f32 v59, v59, v160
    v_exp_f32 v58, v58
    v_exp_f32 v59, v59
    v_sub_f32 v60, v60, v160
    v_sub_f32 v61, v61, v160
    v_exp_f32 v60, v60
    v_exp_f32 v61, v61
    v_mfma_f32_32x32x16_bf16 v[20:35], v[108:111], v[104:107], v[20:35]
    buffer_load_dwordx4 v[108:111], v154, s[12:15], s34 offen
    s_add_u32 s34, s34, 512
    s_min_u32 s34, s34, s40
    v_sub_f32 v62, v62, v160
    v_sub_f32 v63, v63, v160
    v_exp_f32 v62, v62
    v_exp_f32 v63, v63
    v_sub_f32 v64, v64, v160
    v_sub_f32 v65, v65, v160
    v_exp_f32 v64, v64
    v_exp_f32 v65, v65
    v_smfmac_f32_32x32x32_bf16 v[84:99], v[124:127], v[52:59], v158
    v_sub_f32 v66, v66, v160
    v_sub_f32 v67, v67, v160
    v_exp_f32 v66, v66
    v_exp_f32 v67, v67
    v_sub_f32 v4, v4, v159
    v_sub_f32 v5, v5, v159
    v_exp_f32 v4, v4
    v_exp_f32 v5, v5
    v_smfmac_f32_32x32x32_bf16 v[84:99], v[128:131], v[60:67], v158
    s_mov_b64 exec, s[42:43]
    buffer_load_dwordx4 v[124:127], v156, s[12:15], s36 offen
    buffer_load_dwordx4 v[128:131], v157, s[12:15], s36 offen
    s_mov_b64 exec, -1
    s_add_u32 s36, s36, 40960
    s_min_u32 s36, s36, s35
    v_sub_f32 v6, v6, v159
    v_sub_f32 v7, v7, v159
    v_exp_f32 v6, v6
    v_exp_f32 v7, v7
    v_sub_f32 v8, v8, v159
    v_sub_f32 v9, v9, v159
    v_exp_f32 v8, v8
    v_exp_f32 v9, v9
    s_waitcnt vmcnt(7)
    v_mfma_f32_32x32x4_2b_bf16 v[36:67], v[152:153], v[148:149], 0
    v_sub_f32 v10, v10, v159
    v_sub_f32 v11, v11, v159
    v_exp_f32 v10, v10
    v_exp_f32 v11, v11
    v_sub_f32 v12, v12, v159
    v_sub_f32 v13, v13, v159
    v_exp_f32 v12, v12
    buffer_load_dwordx2 v[152:153], v155, s[12:15], s34 offen
    v_exp_f32 v13, v13
    v_sub_f32 v14, v14, v159
    v_sub_f32 v15, v15, v159
    v_exp_f32 v14, v14
    v_exp_f32 v15, v15
    v_sub_f32 v16, v16, v159
    v_sub_f32 v17, v17, v159
    v_exp_f32 v16, v16
    v_exp_f32 v17, v17
    v_smfmac_f32_32x32x32_bf16 v[68:83], v[132:135], v[4:11], v158
    v_sub_f32 v18, v18, v159
    v_sub_f32 v19, v19, v159
    v_exp_f32 v18, v18
    v_exp_f32 v19, v19
    v_sub_f32 v20, v20, v160
    v_sub_f32 v21, v21, v160
    v_exp_f32 v20, v20
    v_exp_f32 v21, v21
    v_smfmac_f32_32x32x32_bf16 v[68:83], v[136:139], v[12:19], v158
    v_sub_f32 v22, v22, v160
    v_sub_f32 v23, v23, v160
    v_exp_f32 v22, v22
    v_exp_f32 v23, v23
    v_sub_f32 v24, v24, v160
    v_sub_f32 v25, v25, v160
    v_exp_f32 v24, v24
    v_exp_f32 v25, v25
    s_waitcnt vmcnt(7)
    v_mfma_f32_32x32x16_bf16 v[36:51], v[112:115], v[100:103], v[36:51]
    v_sub_f32 v26, v26, v160
    v_sub_f32 v27, v27, v160
    v_exp_f32 v26, v26
    v_exp_f32 v27, v27
    v_sub_f32 v28, v28, v160
    v_sub_f32 v29, v29, v160
    v_exp_f32 v28, v28
    v_exp_f32 v29, v29
    v_mfma_f32_32x32x16_bf16 v[52:67], v[112:115], v[104:107], v[52:67]
    buffer_load_dwordx4 v[112:115], v154, s[12:15], s34 offen
    s_add_u32 s34, s34, 512
    s_min_u32 s34, s34, s40
    v_sub_f32 v30, v30, v160
    v_sub_f32 v31, v31, v160
    v_exp_f32 v30, v30
    v_exp_f32 v31, v31
    v_sub_f32 v32, v32, v160
    v_sub_f32 v33, v33, v160
    v_exp_f32 v32, v32
    v_exp_f32 v33, v33
    v_smfmac_f32_32x32x32_bf16 v[84:99], v[132:135], v[20:27], v158
    v_sub_f32 v34, v34, v160
    v_sub_f32 v35, v35, v160
    v_exp_f32 v34, v34
    v_exp_f32 v35, v35
    v_sub_f32 v36, v36, v159
    v_sub_f32 v37, v37, v159
    v_exp_f32 v36, v36
    v_exp_f32 v37, v37
    v_smfmac_f32_32x32x32_bf16 v[84:99], v[136:139], v[28:35], v158
    s_mov_b64 exec, s[42:43]
    buffer_load_dwordx4 v[132:135], v156, s[12:15], s36 offen
    buffer_load_dwordx4 v[136:139], v157, s[12:15], s36 offen
    s_mov_b64 exec, -1
    s_add_u32 s36, s36, 40960
    s_min_u32 s36, s36, s35
    v_sub_f32 v38, v38, v159
    v_sub_f32 v39, v39, v159
    v_exp_f32 v38, v38
    v_exp_f32 v39, v39
    v_sub_f32 v40, v40, v159
    v_sub_f32 v41, v41, v159
    v_exp_f32 v40, v40
    v_exp_f32 v41, v41
    s_waitcnt vmcnt(7)
    v_mfma_f32_32x32x4_2b_bf16 v[4:35], v[150:151], v[148:149], 0
    v_sub_f32 v42, v42, v159
    v_sub_f32 v43, v43, v159
    v_exp_f32 v42, v42
    v_exp_f32 v43, v43
    v_sub_f32 v44, v44, v159
    v_sub_f32 v45, v45, v159
    v_exp_f32 v44, v44
    buffer_load_dwordx2 v[150:151], v155, s[12:15], s34 offen
    v_exp_f32 v45, v45
    s_sub_u32 s37, s37, 2
    v_sub_f32 v46, v46, v159
    v_sub_f32 v47, v47, v159
    v_exp_f32 v46, v46
    v_exp_f32 v47, v47
    v_sub_f32 v48, v48, v159
    v_sub_f32 v49, v49, v159
    v_exp_f32 v48, v48
    v_exp_f32 v49, v49
    v_smfmac_f32_32x32x32_bf16 v[68:83], v[140:143], v[36:43], v158
    v_sub_f32 v50, v50, v159
    v_sub_f32 v51, v51, v159
    v_exp_f32 v50, v50
    v_exp_f32 v51, v51
    v_sub_f32 v52, v52, v160
    v_sub_f32 v53, v53, v160
    v_exp_f32 v52, v52
    v_exp_f32 v53, v53
    v_smfmac_f32_32x32x32_bf16 v[68:83], v[144:147], v[44:51], v158
    v_sub_f32 v54, v54, v160
    v_sub_f32 v55, v55, v160
    v_exp_f32 v54, v54
    v_exp_f32 v55, v55
    v_sub_f32 v56, v56, v160
    v_sub_f32 v57, v57, v160
    v_exp_f32 v56, v56
    v_exp_f32 v57, v57
    s_waitcnt vmcnt(7)
    v_mfma_f32_32x32x16_bf16 v[4:19], v[108:111], v[100:103], v[4:19]
    v_sub_f32 v58, v58, v160
    v_sub_f32 v59, v59, v160
    v_exp_f32 v58, v58
    v_exp_f32 v59, v59
    v_sub_f32 v60, v60, v160
    v_sub_f32 v61, v61, v160
    v_exp_f32 v60, v60
    v_exp_f32 v61, v61
    v_mfma_f32_32x32x16_bf16 v[20:35], v[108:111], v[104:107], v[20:35]
    buffer_load_dwordx4 v[108:111], v154, s[12:15], s34 offen
    s_add_u32 s34, s34, 512
    s_min_u32 s34, s34, s40
    v_sub_f32 v62, v62, v160
    v_sub_f32 v63, v63, v160
    v_exp_f32 v62, v62
    v_exp_f32 v63, v63
    s_cmp_lg_u32 s37, s47
    v_sub_f32 v64, v64, v160
    v_sub_f32 v65, v65, v160
    v_exp_f32 v64, v64
    v_exp_f32 v65, v65
    v_smfmac_f32_32x32x32_bf16 v[84:99], v[140:143], v[52:59], v158
    v_sub_f32 v66, v66, v160
    v_sub_f32 v67, v67, v160
    v_exp_f32 v66, v66
    v_exp_f32 v67, v67
    s_cbranch_scc1 L_k2_loop2
    s_branch L_k2_done
.section .rodata,"a"
.p2align 6
.amdhsa_kernel kf_fused_kernel
  .amdhsa_next_free_vgpr 165
  .amdhsa_next_free_sgpr 52
  .amdhsa_accum_offset 168
  .amdhsa_group_segment_fixed_size 0
  .amdhsa_kernarg_size 80
  .amdhsa_user_sgpr_count 2
  .amdhsa_user_sgpr_kernarg_segment_ptr 1
  .amdhsa_system_sgpr_workgroup_id_x 1
.end_amdhsa_kernel
```
